```python
import torch

def _softmax(x, axis=-1):
    return torch.softmax(x, dim=axis)

def _gelu(x):
    return torch.nn.functional.gelu(x, approximate='tanh')

def _silu(x):
    return torch.nn.functional.silu(x)

def _sigmoid(x):
    return torch.sigmoid(x)

def _layernorm(x, axis=-1, eps=1e-05):
    m = x.mean(dim=axis, keepdim=True)
    v = x.var(dim=axis, keepdim=True, unbiased=False)
    return (x - m) / torch.sqrt(v + eps)

def _scatter_add(tgt, idx, src, axis=0):
    return tgt.clone().index_add_(axis, idx, src)

def _segment_sum(src, seg, n):
    out = torch.zeros((n,) + src.shape[1:], dtype=src.dtype)
    return out.index_add_(0, seg, src)

def _pad(x, pw):
    flat = tuple((v for pair in reversed(pw) for v in pair))
    return torch.nn.functional.pad(x, flat)
kernel_name = 'standalone__factorization_afm__recsys'

def setup_inputs():

    _w = lambda a: (lambda t: t.to(torch.bfloat16) if t.is_floating_point() else t)(torch.as_tensor(a))
    B, F, D, V = (16384, 26, 32, min(1000, 100000))
    A = D
    ii, jj = tuple(torch.triu_indices(F, F, 1).unbind(0))
    return {'idx': _w((lambda lo, hi, *s: torch.randint(lo, hi, s))(0, V, B, F).to(torch.int64)), 'table': _w((lambda *s: torch.randn(*s, dtype=torch.bfloat16) * 0.4)(V, D)), 'ii': _w(ii.to(torch.int64)), 'jj': _w(jj.to(torch.int64)), 'W': _w((lambda *s: torch.randn(*s, dtype=torch.bfloat16) * 1.6)(D, A) * (1.0 / D ** 0.5)), 'b': _w((lambda *s: torch.randn(*s, dtype=torch.bfloat16) * 1.6)(A)), 'h': _w((lambda *s: torch.randn(*s, dtype=torch.bfloat16) * 1.6)(A)), 'p': _w((lambda *s: torch.randn(*s, dtype=torch.bfloat16) * 0.2)(D))}

def reference(idx, table, ii, jj, W, b, h, p):
    emb = table[idx]
    ei = emb[:, ii, :].clone()
    ej = emb[:, jj, :].clone()
    pair = ei * ej
    hid = pair @ W + b
    hid = 0.5 * (hid + torch.abs(hid))
    e = hid @ h
    alpha = _softmax(e, axis=-1)
    pooled = torch.einsum('bp,bpd->bd', alpha, pair)
    return pooled @ p
```

```asm
; @launch grid=(256,1,1) block=(512,1,1) lds=131072
.amdgcn_target "amdgcn-amd-amdhsa--gfx950"
.text
.globl standalone__factorization_afm__recsys_kernel
.p2align 8
.type standalone__factorization_afm__recsys_kernel,@function
standalone__factorization_afm__recsys_kernel:
    s_cmp_ge_u32 s2, 256
    s_cbranch_scc1 L_end
    s_load_dwordx4 s[36:39], s[0:1], 0
    s_load_dwordx8 s[40:47], s[0:1], 32
    s_load_dwordx2 s[50:51], s[0:1], 80
    s_getpc_b64 s[62:63]
    v_lshlrev_b32 v4, 6, v0
    v_min_u32 v4, L_code_end-standalone__factorization_afm__recsys_kernel-64, v4
    v_mov_b32 v5, s63
    v_add_co_u32 v4, vcc, s62, v4
    v_lshrrev_b32 v2, 6, v0
    v_and_b32 v1, 63, v0
    v_addc_co_u32 v5, vcc, 0, v5, vcc
    global_load_dword v135, v[4:5], off
    v_readfirstlane_b32 s52, v2
    v_cmp_lt_u32 vcc, 255, v0
    s_cbranch_vccnz L_hi0
    v_lshrrev_b32 v52, 2, v0
    v_and_b32 v53, 3, v0
    s_mul_i32 s57, s2, 6656
    v_mov_b32 v2, 104
    v_mad_u32_u24 v54, v52, v2, s57
    v_lshl_add_u32 v54, v53, 5, v54
    v_add_u32 v55, 1, v53
    v_lshrrev_b32 v55, 2, v55
    v_mul_i32_i24 v4, -104, v55
    v_add3_u32 v4, v54, v4, 8
    s_waitcnt lgkmcnt(0)
    global_load_dwordx2 v[16:17], v54, s[36:37]
    global_load_dwordx4 v[18:21], v4, s[36:37]
    global_load_dwordx2 v[22:23], v4, s[36:37] offset:16
    s_branch L_lo
L_hi0:
    v_lshrrev_b32 v252, 5, v1
    v_bfe_u32 v5, v1, 3, 2
    s_lshl_b32 s57, s2, 8
    v_lshl_add_u32 v5, v5, 6, s57
    v_lshl_add_u32 v5, v252, 5, v5
    v_min_u32 v5, 63968, v5
    v_and_b32 v4, 7, v1
    v_lshl_add_u32 v4, v2, 3, v4
    v_lshlrev_b32 v4, 1, v4
    v_lshl_add_u32 v4, v252, 10, v4
    v_and_b32 v6, 31, v1
    v_lshlrev_b32 v7, 1, v6
    s_waitcnt lgkmcnt(0)
    global_load_dwordx4 v[136:139], v5, s[38:39]
    global_load_short_d16_hi v120, v4, s[40:41] offset:-64
    global_load_short_d16_hi v185, v7, s[42:43]
    global_load_short_d16_hi v186, v7, s[44:45]
    global_load_short_d16_hi v184, v7, s[46:47]
    s_branch L_hi
L_lo:
    s_setprio 2
    v_mov_b32 v240, -1
    v_mov_b32 v241, -1
    v_mov_b32 v242, -1
    v_mov_b32 v243, -1
    v_lshlrev_b32 v3, 4, v0
    ds_write_b128 v3, v[240:243] offset:32768
    ds_write_b128 v3, v[240:243] offset:40960
    s_and_b32 s60, s52, 3
    v_mov_b32 v4, 0
    v_lshlrev_b32 v5, 2, v0
    ds_write_b32 v5, v4 offset:16640
    v_and_b32 v5, 12, v5
    ds_write_b32 v5, v4
    ds_write_b32 v5, v4 offset:16528
    s_mov_b64 s[4:5], s[36:37]
    s_mov_b32 s6, 0x1a0000
    s_mov_b32 s7, 0x00020000
    v_lshlrev_b32 v44, 2, v53
    v_mul_u32_u24 v4, 13, v55
    v_sub_u32 v4, v44, v4
    v_add_u32 v46, 1, v4
    v_add_u32 v48, 2, v4
    v_add_u32 v50, 3, v4
    s_waitcnt lgkmcnt(0)
    s_load_dword s54, s[50:51], 0x0
    s_load_dwordx16 s[64:79], s[44:45], 0
    s_load_dwordx2 s[48:49], s[0:1], 64
    s_barrier
    s_and_b32 s36, s2, 6
    s_lshl_b32 s36, s36, 5
    s_lshr_b32 s56, s2, 3
    s_lshl_b32 s56, s56, 1
    s_or_b32 s36, s36, s56
    s_and_b32 s56, s2, 1
    s_or_b32 s36, s36, s56
    s_mov_b64 s[8:9], s[38:39]
    s_mov_b32 s10, 0xfa00
    s_mov_b32 s11, 0x00020000
    s_mov_b64 s[12:13], s[40:41]
    s_mov_b32 s14, 0x800
    s_mov_b32 s15, 0x00020000
    v_lshrrev_b32 v130, 5, v1
    v_bfe_u32 v131, v1, 3, 2
    v_lshlrev_b32 v131, 6, v131
    v_lshl_add_u32 v131, v130, 5, v131
    v_and_b32 v133, 31, v1
    v_lshlrev_b32 v132, 6, v133
    v_lshlrev_b32 v133, 1, v133
    s_add_u32 s20, s50, 0x400000
    s_addc_u32 s21, s51, 0
    s_mov_b32 s22, 0x100000
    s_mov_b32 s23, 0x00020000
    s_add_u32 s16, s50, 0x10000
    s_addc_u32 s17, s51, 0
    s_mov_b32 s18, 0x3e8000
    s_mov_b32 s19, 0x00020000
    s_add_u32 s24, s50, 0x800000
    s_addc_u32 s25, s51, 0
    s_mov_b32 s26, 0x800000
    s_mov_b32 s27, 0x00020000
    v_lshlrev_b32 v55, 8, v52
    v_add_u32 v4, 6, v44
    v_lshl_or_b32 v45, v44, 4, v55
    v_lshrrev_b32 v4, 4, v4
    v_lshl_or_b32 v45, v4, 1, v45
    v_or_b32 v44, 1, v45
    v_add_u32 v4, 6, v46
    v_lshl_or_b32 v47, v46, 4, v55
    v_lshrrev_b32 v4, 4, v4
    v_lshl_or_b32 v47, v4, 1, v47
    v_or_b32 v46, 1, v47
    v_add_u32 v4, 6, v48
    v_lshl_or_b32 v49, v48, 4, v55
    v_lshrrev_b32 v4, 4, v4
    v_lshl_or_b32 v49, v4, 1, v49
    v_or_b32 v48, 1, v49
    v_add_u32 v4, 6, v50
    v_lshl_or_b32 v51, v50, 4, v55
    v_lshrrev_b32 v4, 4, v4
    v_lshl_or_b32 v51, v4, 1, v51
    v_or_b32 v50, 1, v51
    v_mov_b32 v8, 0
    v_mov_b32 v24, 0
    v_mov_b32 v9, 0
    v_mov_b32 v25, 0
    v_mov_b32 v10, 0
    v_mov_b32 v26, 0
    v_mov_b32 v11, 0
    v_mov_b32 v27, 0
    v_mov_b32 v12, 0
    v_mov_b32 v28, 0
    v_mov_b32 v13, 0
    v_mov_b32 v29, 0
    v_mov_b32 v14, 0
    v_mov_b32 v30, 0
    v_mov_b32 v15, 0
    v_mov_b32 v31, 0
    v_mov_b32 v2, 2
    v_mov_b32 v7, 0x100010
    v_and_b32 v4, 3, v0
    v_lshlrev_b32 v56, 14, v52
    v_lshl_add_u32 v56, v4, 4, v56
    v_add_u32 v57, 1, v4
    v_lshrrev_b32 v57, 2, v57
    v_sub_u32 v57, 0, v57
    s_lshl_b32 s56, s36, 12
    s_waitcnt vmcnt(0)
    v_lshl_or_b32 v40, v17, 16, v16
    v_lshl_add_u32 v40, v40, 4, v7
    v_lshl_or_b32 v41, v19, 16, v18
    v_lshl_add_u32 v41, v41, 4, v7
    v_lshl_or_b32 v42, v21, 16, v20
    v_lshl_add_u32 v42, v42, 4, v7
    v_lshl_or_b32 v43, v23, 16, v22
    v_lshl_add_u32 v43, v43, 4, v7
    buffer_store_dwordx4 v[40:43], v3, s[20:23], s56 offen sc1
    s_lshl_b32 s57, s2, 8
    buffer_load_dwordx4 v[64:67], v131, s[8:11], s57 offen offset:0
    buffer_load_dwordx4 v[68:71], v131, s[8:11], s57 offen offset:16
    buffer_load_dwordx4 v[88:91], v132, s[12:15], 0 offen offset:0
    buffer_load_dwordx4 v[92:95], v132, s[12:15], 0 offen offset:16
    buffer_load_dwordx4 v[96:99], v132, s[12:15], 0 offen offset:32
    buffer_load_dwordx4 v[100:103], v132, s[12:15], 0 offen offset:48
    global_load_short_d16_hi v128, v133, s[46:47]
    v_and_b32 v32, -4, v16
    ds_add_rtn_u32 v24, v32, v2 offset:16640
    v_and_b32 v33, -4, v17
    ds_add_rtn_u32 v25, v33, v2 offset:16640
    s_mov_b32 exec_lo, 0x77777777
    s_mov_b32 exec_hi, 0x77777777
    v_and_b32 v34, -4, v18
    ds_add_rtn_u32 v26, v34, v2 offset:16640
    v_and_b32 v35, -4, v19
    ds_add_rtn_u32 v27, v35, v2 offset:16640
    v_and_b32 v36, -4, v20
    ds_add_rtn_u32 v28, v36, v2 offset:16640
    v_and_b32 v37, -4, v21
    ds_add_rtn_u32 v29, v37, v2 offset:16640
    v_and_b32 v38, -4, v22
    ds_add_rtn_u32 v30, v38, v2 offset:16640
    v_and_b32 v39, -4, v23
    ds_add_rtn_u32 v31, v39, v2 offset:16640
    s_mov_b64 exec, -1
    v_lshlrev_b32 v16, 2, v16
    v_and_or_b32 v16, v16, 12, v44
    v_lshlrev_b32 v17, 2, v17
    v_and_or_b32 v17, v17, 12, v45
    v_lshlrev_b32 v18, 2, v18
    v_and_or_b32 v18, v18, 12, v46
    v_lshlrev_b32 v19, 2, v19
    v_and_or_b32 v19, v19, 12, v47
    v_lshlrev_b32 v20, 2, v20
    v_and_or_b32 v20, v20, 12, v48
    v_lshlrev_b32 v21, 2, v21
    v_and_or_b32 v21, v21, 12, v49
    v_lshlrev_b32 v22, 2, v22
    v_and_or_b32 v22, v22, 12, v50
    v_lshlrev_b32 v23, 2, v23
    v_and_or_b32 v23, v23, 12, v51
    s_waitcnt lgkmcnt(0)
    v_min_u32 v4, 54, v24
    v_lshl_add_u32 v4, v32, 4, v4
    ds_write_b16 v4, v16 offset:32768
    v_min_u32 v4, 54, v25
    v_lshl_add_u32 v4, v33, 4, v4
    ds_write_b16 v4, v17 offset:32768
    s_mov_b32 exec_lo, 0x77777777
    s_mov_b32 exec_hi, 0x77777777
    v_min_u32 v4, 54, v26
    v_lshl_add_u32 v4, v34, 4, v4
    ds_write_b16 v4, v18 offset:32768
    v_min_u32 v4, 54, v27
    v_lshl_add_u32 v4, v35, 4, v4
    ds_write_b16 v4, v19 offset:32768
    v_min_u32 v4, 54, v28
    v_lshl_add_u32 v4, v36, 4, v4
    ds_write_b16 v4, v20 offset:32768
    v_min_u32 v4, 54, v29
    v_lshl_add_u32 v4, v37, 4, v4
    ds_write_b16 v4, v21 offset:32768
    v_min_u32 v4, 54, v30
    v_lshl_add_u32 v4, v38, 4, v4
    ds_write_b16 v4, v22 offset:32768
    v_min_u32 v4, 54, v31
    v_lshl_add_u32 v4, v39, 4, v4
    ds_write_b16 v4, v23 offset:32768
    s_mov_b64 exec, -1
    s_lshl_b32 s56, s36, 6
    s_add_u32 s54, s54, 1
    s_mov_b64 s[28:29], s[48:49]
    s_mov_b32 s30, 0x8000
    s_mov_b32 s31, 0x00020000
    v_mov_b32 v7, s54
    s_waitcnt vmcnt(7) lgkmcnt(0)
    v_mov_b32 v5, 17640
    v_mov_b32 v6, 1
    s_mov_b64 exec, 1
    ds_add_u32 v5, v6
    s_mov_b64 exec, -1
    v_mov_b32 v5, 17640
L_sync_lo:
    ds_read_b32 v6, v5
    s_waitcnt lgkmcnt(0)
    v_cmp_gt_u32 vcc, 4, v6
    s_cbranch_vccnz L_sync_lo
    s_cmp_ge_u32 s60, 2
    s_cbranch_scc1 L_nopub
    v_and_b32 v4, -4, v0
    ds_read_b128 v[146:149], v3 offset:32768
    ds_read_b32 v216, v4 offset:16640
    ds_read_b128 v[150:153], v3 offset:34816
    ds_read_b32 v217, v4 offset:16768
    ds_read_b128 v[154:157], v3 offset:36864
    ds_read_b32 v218, v4 offset:16896
    ds_read_b128 v[158:161], v3 offset:38912
    ds_read_b32 v219, v4 offset:17024
    ds_read_b128 v[162:165], v3 offset:40960
    ds_read_b32 v220, v4 offset:17152
    ds_read_b128 v[202:205], v3 offset:43008
    ds_read_b32 v221, v4 offset:17280
    ds_read_b128 v[206:209], v3 offset:45056
    ds_read_b32 v222, v4 offset:17408
    s_waitcnt lgkmcnt(12)
    ds_read_b128 v[210:213], v3 offset:47104
    ds_read_b32 v223, v4 offset:17536
    v_bfi_b32 v149, v57, v7, v149
    v_bfi_b32 v148, v57, v216, v148
    buffer_store_dwordx4 v[146:149], v56, s[16:19], s56 offen sc1
    s_add_u32 s56, s56, 0x80000
    s_waitcnt lgkmcnt(12)
    v_bfi_b32 v153, v57, v7, v153
    v_bfi_b32 v152, v57, v217, v152
    buffer_store_dwordx4 v[150:153], v56, s[16:19], s56 offen sc1
    s_add_u32 s56, s56, 0x80000
    s_waitcnt lgkmcnt(10)
    v_bfi_b32 v157, v57, v7, v157
    v_bfi_b32 v156, v57, v218, v156
    buffer_store_dwordx4 v[154:157], v56, s[16:19], s56 offen sc1
    s_add_u32 s56, s56, 0x80000
    s_waitcnt lgkmcnt(8)
    v_bfi_b32 v161, v57, v7, v161
    v_bfi_b32 v160, v57, v219, v160
    buffer_store_dwordx4 v[158:161], v56, s[16:19], s56 offen sc1
    s_add_u32 s56, s56, 0x80000
    s_waitcnt lgkmcnt(6)
    v_bfi_b32 v165, v57, v7, v165
    v_bfi_b32 v164, v57, v220, v164
    buffer_store_dwordx4 v[162:165], v56, s[16:19], s56 offen sc1
    s_add_u32 s56, s56, 0x80000
    s_waitcnt lgkmcnt(4)
    v_bfi_b32 v205, v57, v7, v205
    v_bfi_b32 v204, v57, v221, v204
    buffer_store_dwordx4 v[202:205], v56, s[16:19], s56 offen sc1
    s_add_u32 s56, s56, 0x80000
    s_waitcnt lgkmcnt(2)
    v_bfi_b32 v209, v57, v7, v209
    v_bfi_b32 v208, v57, v222, v208
    buffer_store_dwordx4 v[206:209], v56, s[16:19], s56 offen sc1
    s_add_u32 s56, s56, 0x80000
    s_waitcnt lgkmcnt(0)
    v_bfi_b32 v213, v57, v7, v213
    v_bfi_b32 v212, v57, v223, v212
    buffer_store_dwordx4 v[210:213], v56, s[16:19], s56 offen sc1
    s_waitcnt vmcnt(8)
    s_branch L_noa5
L_nopub:
    s_and_b32 s57, s60, 1
    s_mul_i32 s56, s57, 384
    v_lshl_add_u32 v134, v1, 2, s56
    v_mov_b32 v6, 0
    v_lshl_add_u32 v4, v133, 1, s56
    ds_write_b32 v4, v6 offset:18176
    s_lshl_b32 s58, s57, 2
    v_and_b32 v4, 7, v1
    v_subrev_u32 v4, s58, v4
    v_min_u32 v4, 2, v4
    v_lshlrev_b32 v4, 7, v4
    v_lshl_add_u32 v4, v130, 6, v4
    v_add_u32 v132, s56, v4
    s_lshl_b32 s57, s57, 11
    v_lshl_add_u32 v131, v1, 4, s57
    v_cmp_gt_u32 vcc, 32, v1
    s_waitcnt vmcnt(0)
    v_dot2_f32_bf16 v6, v88, s64, v6
    v_dot2_f32_bf16 v6, v89, s65, v6
    v_dot2_f32_bf16 v6, v90, s66, v6
    v_dot2_f32_bf16 v6, v91, s67, v6
    v_dot2_f32_bf16 v6, v92, s68, v6
    v_dot2_f32_bf16 v6, v93, s69, v6
    v_dot2_f32_bf16 v6, v94, s70, v6
    v_dot2_f32_bf16 v6, v95, s71, v6
    v_dot2_f32_bf16 v6, v96, s72, v6
    v_dot2_f32_bf16 v6, v97, s73, v6
    v_dot2_f32_bf16 v6, v98, s74, v6
    v_dot2_f32_bf16 v6, v99, s75, v6
    v_dot2_f32_bf16 v6, v100, s76, v6
    v_dot2_f32_bf16 v6, v101, s77, v6
    v_dot2_f32_bf16 v6, v102, s78, v6
    v_dot2_f32_bf16 v6, v103, s79, v6
    v_lshlrev_b32 v72, 16, v64
    v_and_b32 v73, 0xffff0000, v64
    v_lshlrev_b32 v74, 16, v65
    v_and_b32 v75, 0xffff0000, v65
    v_lshlrev_b32 v76, 16, v66
    v_and_b32 v77, 0xffff0000, v66
    v_lshlrev_b32 v78, 16, v67
    v_and_b32 v79, 0xffff0000, v67
    v_lshlrev_b32 v80, 16, v68
    v_and_b32 v81, 0xffff0000, v68
    v_lshlrev_b32 v82, 16, v69
    v_and_b32 v83, 0xffff0000, v69
    v_lshlrev_b32 v84, 16, v70
    v_and_b32 v85, 0xffff0000, v70
    v_lshlrev_b32 v86, 16, v71
    v_and_b32 v87, 0xffff0000, v71
    v_mul_f32 v6, 0x3f38aa3b, v6
    v_cndmask_b32 v6, v128, v6, vcc
    ds_write_b32 v134, v6 offset:17920
    s_waitcnt lgkmcnt(0)
    ds_read_b128 v[104:107], v132 offset:17920
    ds_read_b128 v[108:111], v132 offset:17936
    ds_read_b128 v[112:115], v132 offset:17952
    ds_read_b128 v[116:119], v132 offset:17968
    s_waitcnt lgkmcnt(0)
    v_mul_f32 v104, v104, v72
    v_mul_f32 v105, v105, v73
    v_mul_f32 v106, v106, v74
    v_mul_f32 v107, v107, v75
    v_mul_f32 v108, v108, v76
    v_mul_f32 v109, v109, v77
    v_mul_f32 v110, v110, v78
    v_mul_f32 v111, v111, v79
    v_mul_f32 v112, v112, v80
    v_mul_f32 v113, v113, v81
    v_mul_f32 v114, v114, v82
    v_mul_f32 v115, v115, v83
    v_mul_f32 v116, v116, v84
    v_mul_f32 v117, v117, v85
    v_mul_f32 v118, v118, v86
    v_mul_f32 v119, v119, v87
    v_cvt_pk_bf16_f32 v120, v104, v105
    v_cvt_pk_bf16_f32 v121, v106, v107
    v_cvt_pk_bf16_f32 v122, v108, v109
    v_cvt_pk_bf16_f32 v123, v110, v111
    v_cvt_pk_bf16_f32 v124, v112, v113
    v_cvt_pk_bf16_f32 v125, v114, v115
    v_cvt_pk_bf16_f32 v126, v116, v117
    v_cvt_pk_bf16_f32 v127, v118, v119
    ds_write_b128 v131, v[120:123] offset:28672
    ds_write_b128 v131, v[124:127] offset:29696
    s_waitcnt lgkmcnt(0)
    v_mov_b32 v5, 17648
    v_mov_b32 v6, 1
    s_mov_b64 exec, 1
    ds_add_u32 v5, v6
    s_mov_b64 exec, -1
L_noa5:
    v_mov_b32 v7, 32768
    v_lshl_add_u32 v4, v32, 3, v24
    v_lshl_add_u32 v8, v4, 1, v7
    v_lshl_add_u32 v4, v33, 3, v25
    v_lshl_add_u32 v9, v4, 1, v7
    s_mov_b32 exec_lo, 0x77777777
    s_mov_b32 exec_hi, 0x77777777
    v_lshl_add_u32 v4, v34, 3, v26
    v_lshl_add_u32 v10, v4, 1, v7
    v_lshl_add_u32 v4, v35, 3, v27
    v_lshl_add_u32 v11, v4, 1, v7
    v_lshl_add_u32 v4, v36, 3, v28
    v_lshl_add_u32 v12, v4, 1, v7
    v_lshl_add_u32 v4, v37, 3, v29
    v_lshl_add_u32 v13, v4, 1, v7
    v_lshl_add_u32 v4, v38, 3, v30
    v_lshl_add_u32 v14, v4, 1, v7
    v_lshl_add_u32 v4, v39, 3, v31
    v_lshl_add_u32 v15, v4, 1, v7
    s_mov_b64 exec, -1
    v_max3_u32 v7, v24, v25, v26
    v_max3_u32 v7, v7, v27, v28
    v_max3_u32 v7, v7, v29, v30
    v_max_u32 v7, v7, v31
    v_cmp_le_u32 vcc, 32, v7
    s_cbranch_vccnz L_mark
L_mark_ret:
    s_cmp_ge_u32 s2, 250
    s_cbranch_scc1 L_nobucket0
    s_setprio 0
    v_and_b32 v4, 15, v1
    v_bfe_u32 v5, v1, 4, 1
    v_lshrrev_b32 v248, 5, v1
    s_mul_i32 s33, s60, 8192
    s_add_u32 s33, s33, 65536
    s_lshl_b32 s32, s60, 18
    s_lshl_b32 s34, s60, 13
    s_add_u32 s34, s34, 98304
    v_and_b32 v250, 31, v1
    v_lshl_add_u32 v250, v250, 2, s33
    v_lshrrev_b32 v7, 4, v1
    v_lshl_add_u32 v199, v7, 5, v4
    v_lshl_add_u32 v199, v199, 2, s33
    v_add_u32 v246, -1, v248
    v_and_b32 v246, 0xffff0000, v246
    v_mul_u32_u24 v247, 12, v248
    v_mul_i32_i24 v249, -52, v248
    v_mov_b32 v251, 0x7ffffffe
    v_mov_b32 v198, 0x2003fffc
    v_and_b32 v6, 1, v4
    v_lshlrev_b32 v6, 4, v6
    v_lshrrev_b32 v6, v6, 1.0
    v_bfe_u32 v7, v4, 1, 1
    v_xor_b32 v7, v7, v5
    v_add_u32 v7, -1, v7
    v_and_b32 v6, v6, v7
    v_lshrrev_b32 v7, 2, v4
    v_xor_b32 v4, 0, v7
    v_add_u32 v4, -1, v4
    v_ashrrev_i32 v4, 31, v4
    v_and_b32 v166, v4, v6
    v_mov_b32 v167, v166
    v_mov_b32 v168, v166
    v_mov_b32 v169, v166
    v_xor_b32 v4, 1, v7
    v_add_u32 v4, -1, v4
    v_ashrrev_i32 v4, 31, v4
    v_and_b32 v170, v4, v6
    v_mov_b32 v171, v170
    v_mov_b32 v172, v170
    v_mov_b32 v173, v170
    v_xor_b32 v4, 2, v7
    v_add_u32 v4, -1, v4
    v_ashrrev_i32 v4, 31, v4
    v_and_b32 v174, v4, v6
    v_mov_b32 v175, v174
    v_mov_b32 v176, v174
    v_mov_b32 v177, v174
    v_xor_b32 v4, 3, v7
    v_add_u32 v4, -1, v4
    v_ashrrev_i32 v4, 31, v4
    v_and_b32 v178, v4, v6
    v_mov_b32 v179, v178
    v_mov_b32 v180, v178
    v_mov_b32 v181, v178
    v_mov_b32 v237, 0
    v_mov_b32 v245, 0
    v_and_b32 v4, 3, v1
    v_lshrrev_b32 v5, 2, v1
    v_lshlrev_b32 v200, 10, v4
    v_lshl_add_u32 v200, v5, 2, v200
    v_add_u32 v200, s34, v200
    v_lshlrev_b32 v4, 4, v4
    v_lshl_add_u32 v201, v5, 14, v4
    s_lshl_b32 s35, s60, 20
    s_lshl_b32 s56, s2, 6
    s_add_u32 s35, s35, s56
    s_lshl_b32 s61, s60, 12
    v_lshrrev_b32 v4, 4, v1
    v_xor_b32 v4, v4, v1
    v_and_b32 v4, 3, v4
    v_and_b32 v5, 60, v1
    v_or_b32 v4, v4, v5
    v_lshl_add_u32 v140, v4, 4, s61
    v_lshrrev_b32 v4, 2, v1
    v_lshl_add_u32 v5, v1, 6, s61
    v_xor_b32 v6, 0, v4
    v_and_b32 v6, 3, v6
    v_lshl_add_u32 v141, v6, 4, v5
    v_xor_b32 v6, 1, v4
    v_and_b32 v6, 3, v6
    v_lshl_add_u32 v142, v6, 4, v5
    v_xor_b32 v6, 2, v4
    v_and_b32 v6, 3, v6
    v_lshl_add_u32 v143, v6, 4, v5
    v_xor_b32 v6, 3, v4
    v_and_b32 v6, 3, v6
    v_lshl_add_u32 v144, v6, 4, v5
    v_lshl_add_u32 v4, v1, 4, s33
    ds_write_b128 v4, v[240:243] offset:0
    ds_write_b128 v4, v[240:243] offset:1024
    ds_write_b128 v4, v[240:243] offset:2048
    ds_write_b128 v4, v[240:243] offset:3072
    ds_write_b128 v4, v[240:243] offset:4096
    ds_write_b128 v4, v[240:243] offset:5120
    ds_write_b128 v4, v[240:243] offset:6144
    ds_write_b128 v4, v[240:243] offset:7168
    s_and_b32 s56, s54, 255
    s_xor_b32 s57, s54, 1
    s_and_b32 s57, s57, 3
    s_lshl_b32 s57, s57, 8
    s_or_b32 s56, s56, s57
    s_lshr_b32 s57, s54, 8
    s_lshl_b32 s57, s57, 10
    s_or_b32 s56, s56, s57
    v_and_b32 v4, 3, v0
    v_lshlrev_b32 v4, 3, v4
    v_lshrrev_b32 v4, v4, s56
    v_bfe_u32 v5, v4, 0, 2
    v_alignbit_b32 v252, v5, v5, 1
    v_bfe_u32 v5, v4, 2, 2
    v_alignbit_b32 v253, v5, v5, 1
    v_bfe_u32 v5, v4, 4, 2
    v_alignbit_b32 v254, v5, v5, 1
    v_bfe_u32 v5, v4, 6, 2
    v_alignbit_b32 v255, v5, v5, 1
    s_setprio 2
    v_lshlrev_b32 v3, 4, v1
    s_lshl_b32 s56, s2, 14
    s_add_u32 s56, s56, s61
    s_mov_b32 s58, 0
    s_mov_b32 s62, 0x88888888
    s_mov_b32 s63, 0x88888888
    v_lshlrev_b32 v210, 14, v1
    v_mov_b32 v212, 19456
    v_lshl_add_u32 v213, v1, 2, s33
    s_and_b32 s57, s60, 1
    s_lshl_b32 s57, s57, 2
    s_add_u32 s57, s57, 16528
    v_mov_b32 v2, s57
    s_cmp_ge_u32 s60, 2
    s_cbranch_scc1 L_poller
L_wait_lists:
    s_sleep 1
    ds_read_b32 v4, v2
    s_waitcnt lgkmcnt(0)
    v_cmp_eq_u32 vcc, 0, v4
    s_cbranch_vccnz L_wait_lists
    v_cmp_eq_u32 vcc, 1, v4
    s_cbranch_vccnz L_poll1_ok
    s_branch L_gaveup
L_poller:
    s_sub_u32 s57, s56, 0x2000
    v_add_u32 v7, 0xffffe000, v140
    s_sleep 16
L_poll1:
    buffer_load_dwordx4 v[16:19], v3, s[16:19], s57 offen offset:0 sc1
    buffer_load_dwordx4 v[20:23], v3, s[16:19], s57 offen offset:1024 sc1
    buffer_load_dwordx4 v[24:27], v3, s[16:19], s57 offen offset:2048 sc1
    buffer_load_dwordx4 v[28:31], v3, s[16:19], s57 offen offset:3072 sc1
    buffer_load_dwordx4 v[32:35], v3, s[16:19], s56 offen offset:0 sc1
    buffer_load_dwordx4 v[36:39], v3, s[16:19], s56 offen offset:1024 sc1
    buffer_load_dwordx4 v[40:43], v3, s[16:19], s56 offen offset:2048 sc1
    buffer_load_dwordx4 v[44:47], v3, s[16:19], s56 offen offset:3072 sc1
    s_waitcnt vmcnt(7)
    v_xor_b32 v4, s54, v19
    ds_write_b128 v7, v[16:19] offset:49152
    s_waitcnt vmcnt(6)
    v_xor_b32 v5, s54, v23
    v_or_b32 v4, v4, v5
    ds_write_b128 v7, v[20:23] offset:50176
    s_waitcnt vmcnt(5)
    v_xor_b32 v5, s54, v27
    v_or_b32 v4, v4, v5
    ds_write_b128 v7, v[24:27] offset:51200
    s_waitcnt vmcnt(4)
    v_xor_b32 v5, s54, v31
    v_or_b32 v4, v4, v5
    ds_write_b128 v7, v[28:31] offset:52224
    s_waitcnt vmcnt(3)
    v_xor_b32 v5, s54, v35
    v_or_b32 v4, v4, v5
    ds_write_b128 v140, v[32:35] offset:49152
    s_waitcnt vmcnt(2)
    v_xor_b32 v5, s54, v39
    v_or_b32 v4, v4, v5
    ds_write_b128 v140, v[36:39] offset:50176
    s_waitcnt vmcnt(1)
    v_xor_b32 v5, s54, v43
    v_or_b32 v4, v4, v5
    ds_write_b128 v140, v[40:43] offset:51200
    s_waitcnt vmcnt(0)
    v_xor_b32 v5, s54, v47
    v_or_b32 v4, v4, v5
    ds_write_b128 v140, v[44:47] offset:52224
    v_cmp_ne_u32 vcc, 0, v4
    s_and_b64 vcc, vcc, s[62:63]
    v_mov_b32 v5, 1
    s_waitcnt lgkmcnt(0)
    s_cbranch_vccnz L_poll1_again
    ds_write_b32 v2, v5
L_poll1_ok:
    ds_read_b128 v[96:99], v141 offset:49152
    ds_read_b128 v[108:111], v144 offset:49152
    ds_read_b128 v[100:103], v142 offset:49152
    ds_read_b128 v[104:107], v143 offset:49152
    s_waitcnt lgkmcnt(3)
    v_or_b32_sdwa v6, v210, sext(v96) dst_sel:DWORD dst_unused:UNUSED_PAD src0_sel:DWORD src1_sel:WORD_0
    ds_write_b32 v213, v6 offset:0
    v_add_u32 v5, 0x100000, v210
    v_or_b32_sdwa v7, v5, sext(v96) dst_sel:DWORD dst_unused:UNUSED_PAD src0_sel:DWORD src1_sel:WORD_1
    ds_write_b32 v213, v7 offset:256
    ds_read_b32 v80, v250 offset:0
    ds_read_b32 v81, v250 offset:128
    ds_read_b32 v82, v250 offset:256
    ds_read_b32 v83, v250 offset:384
    s_waitcnt lgkmcnt(8)
    v_lshrrev_b32 v2, 1, v110
    v_min_u32 v2, 24, v2
    v_sub_u32 v2, v2, 2 clamp
    v_mov_b32 v3, v2
    s_nop 1
    v_add_u32_dpp v3, v3, v3 row_shr:1 row_mask:0xf bank_mask:0xf
    s_waitcnt lgkmcnt(0)
    v_lshrrev_b32 v112, 2, v80
    v_bfe_i32 v116, v80, v248, 1
    v_lshrrev_b32 v113, 2, v81
    v_add_u32_dpp v3, v3, v3 row_shr:2 row_mask:0xf bank_mask:0xf
    v_bfe_i32 v117, v81, v248, 1
    v_lshrrev_b32 v114, 2, v82
    v_bfe_i32 v118, v82, v248, 1
    v_add_u32_dpp v3, v3, v3 row_shr:4 row_mask:0xf bank_mask:0xf
    v_lshrrev_b32 v115, 2, v83
    v_bfe_i32 v119, v83, v248, 1
    v_and_b32 v112, v112, v198
    v_add_u32_dpp v3, v3, v3 row_shr:8 row_mask:0xf bank_mask:0xf
    v_and_b32 v120, v116, v249
    v_and_b32 v113, v113, v198
    v_and_b32 v121, v117, v249
    v_add_u32_dpp v3, v3, v3 row_bcast:15 row_mask:0xa bank_mask:0xf
    v_and_b32 v114, v114, v198
    v_and_b32 v122, v118, v249
    v_and_b32 v115, v115, v198
    v_add_u32_dpp v3, v3, v3 row_bcast:31 row_mask:0xc bank_mask:0xf
    v_and_b32 v123, v119, v249
    v_add3_u32 v112, v112, v247, v120
    v_and_b32 v116, v116, v246
    v_add3_u32 v113, v113, v247, v121
    v_and_b32 v117, v117, v246
    v_add3_u32 v114, v114, v247, v122
    v_and_b32 v118, v118, v246
    v_add3_u32 v115, v115, v247, v123
    v_and_b32 v119, v119, v246
    buffer_load_dwordx4 v[16:19], v112, s[20:23], s32 offen sc1
    v_and_or_b32 v80, v80, 12, v116
    buffer_load_dwordx4 v[20:23], v113, s[20:23], s32 offen sc1
    v_and_or_b32 v81, v81, 12, v117
    buffer_load_dwordx4 v[24:27], v114, s[20:23], s32 offen sc1
    v_and_or_b32 v82, v82, 12, v118
    buffer_load_dwordx4 v[28:31], v115, s[20:23], s32 offen sc1
    v_and_or_b32 v83, v83, 12, v119
    v_cmp_eq_u32 vcc, 0, v2
    v_readlane_b32 s58, v3, 63
    v_sub_u32 v211, v3, v2
    v_lshl_add_u32 v3, v211, 2, s33
    v_cndmask_b32 v3, v3, v212, vcc
    v_cmp_lt_u32 vcc, 14, v2
    s_or_b32 s59, vcc_lo, vcc_hi
    s_add_u32 s58, s58, 128
    s_waitcnt lgkmcnt(0)
    s_cbranch_vccnz L_fl23
    v_cmp_lt_u32 vcc, 12, v2
    v_add_u32 v5, 0xf00000, v210
    s_cbranch_vccnz L_fl15
    v_add_u32 v5, 0xd00000, v210
    s_branch L_fl13
L_fl15:
    v_or_b32_sdwa v7, v5, sext(v103) dst_sel:DWORD dst_unused:UNUSED_PAD src0_sel:DWORD src1_sel:WORD_1
    v_add_u32 v5, 0xfff00000, v5
    ds_write_b32 v3, v7 offset:564
    v_or_b32_sdwa v6, v5, sext(v103) dst_sel:DWORD dst_unused:UNUSED_PAD src0_sel:DWORD src1_sel:WORD_0
    v_add_u32 v5, 0xfff00000, v5
    ds_write_b32 v3, v6 offset:560
L_fl13:
    v_or_b32_sdwa v7, v5, sext(v102) dst_sel:DWORD dst_unused:UNUSED_PAD src0_sel:DWORD src1_sel:WORD_1
    v_add_u32 v5, 0xfff00000, v5
    ds_write_b32 v3, v7 offset:556
    v_or_b32_sdwa v6, v5, sext(v102) dst_sel:DWORD dst_unused:UNUSED_PAD src0_sel:DWORD src1_sel:WORD_0
    v_add_u32 v5, 0xfff00000, v5
    ds_write_b32 v3, v6 offset:552
    v_or_b32_sdwa v7, v5, sext(v101) dst_sel:DWORD dst_unused:UNUSED_PAD src0_sel:DWORD src1_sel:WORD_1
    v_add_u32 v5, 0xfff00000, v5
    ds_write_b32 v3, v7 offset:548
    v_or_b32_sdwa v6, v5, sext(v101) dst_sel:DWORD dst_unused:UNUSED_PAD src0_sel:DWORD src1_sel:WORD_0
    v_add_u32 v5, 0xfff00000, v5
    ds_write_b32 v3, v6 offset:544
    v_or_b32_sdwa v7, v5, sext(v100) dst_sel:DWORD dst_unused:UNUSED_PAD src0_sel:DWORD src1_sel:WORD_1
    v_add_u32 v5, 0xfff00000, v5
    ds_write_b32 v3, v7 offset:540
    v_or_b32_sdwa v6, v5, sext(v100) dst_sel:DWORD dst_unused:UNUSED_PAD src0_sel:DWORD src1_sel:WORD_0
    v_add_u32 v5, 0xfff00000, v5
    ds_write_b32 v3, v6 offset:536
    s_waitcnt lgkmcnt(4)
    v_or_b32_sdwa v7, v5, sext(v99) dst_sel:DWORD dst_unused:UNUSED_PAD src0_sel:DWORD src1_sel:WORD_1
    v_add_u32 v5, 0xfff00000, v5
    ds_write_b32 v3, v7 offset:532
    v_or_b32_sdwa v6, v5, sext(v99) dst_sel:DWORD dst_unused:UNUSED_PAD src0_sel:DWORD src1_sel:WORD_0
    v_add_u32 v5, 0xfff00000, v5
    ds_write_b32 v3, v6 offset:528
    v_or_b32_sdwa v7, v5, sext(v98) dst_sel:DWORD dst_unused:UNUSED_PAD src0_sel:DWORD src1_sel:WORD_1
    v_add_u32 v5, 0xfff00000, v5
    ds_write_b32 v3, v7 offset:524
    v_or_b32_sdwa v6, v5, sext(v98) dst_sel:DWORD dst_unused:UNUSED_PAD src0_sel:DWORD src1_sel:WORD_0
    v_add_u32 v5, 0xfff00000, v5
    ds_write_b32 v3, v6 offset:520
    v_or_b32_sdwa v7, v5, sext(v97) dst_sel:DWORD dst_unused:UNUSED_PAD src0_sel:DWORD src1_sel:WORD_1
    v_add_u32 v5, 0xfff00000, v5
    ds_write_b32 v3, v7 offset:516
    v_or_b32_sdwa v6, v5, sext(v97) dst_sel:DWORD dst_unused:UNUSED_PAD src0_sel:DWORD src1_sel:WORD_0
    ds_write_b32 v3, v6 offset:512
    v_add_u32 v7, 1024, v199
    v_mov_b32 v6, v199
    s_waitcnt lgkmcnt(3)
    ds_read_b32 v84, v250 offset:512
    ds_read_b32 v85, v250 offset:640
    ds_read_b32 v86, v250 offset:768
    ds_read_b32 v87, v250 offset:896
    ds_read_b32 v88, v250 offset:1024
    ds_read_b32 v89, v250 offset:1152
    ds_read_b32 v90, v250 offset:1280
    ds_read_b32 v91, v250 offset:1408
    ds_read_b32 v92, v250 offset:1536
    ds_read_b32 v93, v250 offset:1664
    ds_read_b32 v94, v250 offset:1792
    ds_read_b32 v95, v250 offset:1920
    v_readlane_b32 s56, v211, 16
    v_readlane_b32 s57, v211, 32
    v_readlane_b32 s55, v211, 48
    v_add_u32 v214, 64, v200
    v_add_u32 v215, 128, v200
    v_add_u32 v216, 192, v200
    s_cmp_le_u32 s56, 128
    s_cselect_b32 s3, 1, 0
    s_cmp_le_u32 s57, 256
    s_cselect_b32 s56, 2, 0
    s_or_b32 s3, s3, s56
    s_cmp_le_u32 s55, 256
    s_cselect_b32 s56, 4, 0
    s_or_b32 s3, s3, s56
    s_mov_b32 s61, 0
L_round:
    s_add_u32 s55, s58, 31
    s_lshr_b32 s55, s55, 5
    s_waitcnt lgkmcnt(10)
    v_lshrrev_b32 v112, 2, v84
    v_bfe_i32 v116, v84, v248, 1
    v_lshrrev_b32 v113, 2, v85
    v_bfe_i32 v117, v85, v248, 1
    v_and_b32 v112, v112, v198
    v_and_b32 v120, v116, v249
    v_and_b32 v113, v113, v198
    v_and_b32 v121, v117, v249
    v_add3_u32 v112, v112, v247, v120
    v_and_b32 v116, v116, v246
    v_add3_u32 v113, v113, v247, v121
    v_and_b32 v117, v117, v246
    buffer_load_dwordx4 v[32:35], v112, s[20:23], s32 offen sc1
    v_and_or_b32 v84, v84, 12, v116
    buffer_load_dwordx4 v[36:39], v113, s[20:23], s32 offen sc1
    v_and_or_b32 v85, v85, 12, v117
    ds_read2_b32 v[202:203], v6 offset0:0 offset1:16
    ds_read2_b32 v[204:205], v6 offset0:128 offset1:144
    ds_read2_b32 v[206:207], v7 offset0:0 offset1:16
    ds_read2_b32 v[208:209], v7 offset0:128 offset1:144
    v_mov_b32 v5, 17660
    s_branch L_sync_tab
L_sync_tab_z:
    s_sleep 1
L_sync_tab:
    ds_read_b32 v6, v5
    s_waitcnt lgkmcnt(0)
    v_cmp_gt_u32 vcc, 4, v6
    s_cbranch_vccnz L_sync_tab_z
    v_mov_b32 v5, 0x1ffc
    v_mov_b32 v6, s34
    v_lshrrev_b32 v202, 12, v202
    v_lshrrev_b32 v203, 12, v203
    v_lshrrev_b32 v204, 12, v204
    v_lshrrev_b32 v205, 12, v205
    v_lshrrev_b32 v206, 12, v206
    v_lshrrev_b32 v207, 12, v207
    v_lshrrev_b32 v208, 12, v208
    v_lshrrev_b32 v209, 12, v209
    v_and_or_b32 v202, v202, v5, v6
    v_and_or_b32 v203, v203, v5, v6
    v_and_or_b32 v204, v204, v5, v6
    v_and_or_b32 v205, v205, v5, v6
    v_and_or_b32 v206, v206, v5, v6
    v_and_or_b32 v207, v207, v5, v6
    v_and_or_b32 v208, v208, v5, v6
    v_and_or_b32 v209, v209, v5, v6
    s_waitcnt vmcnt(5)
    v_and_b32 v16, v16, v80
    v_add_u32_sdwa v2, v80, v17 dst_sel:DWORD dst_unused:UNUSED_PAD src0_sel:WORD_0 src1_sel:WORD_0
    ds_read_b32 v230, v2
    v_add_u32_sdwa v17, v80, v17 dst_sel:DWORD dst_unused:UNUSED_PAD src0_sel:WORD_0 src1_sel:WORD_1
    ds_read_b32 v231, v17
    v_add_u32_sdwa v3, v80, v18 dst_sel:DWORD dst_unused:UNUSED_PAD src0_sel:WORD_0 src1_sel:WORD_0
    ds_read_b32 v232, v3
    v_add_u32_sdwa v18, v80, v18 dst_sel:DWORD dst_unused:UNUSED_PAD src0_sel:WORD_0 src1_sel:WORD_1
    ds_read_b32 v233, v18
    v_add_u32_sdwa v4, v80, v19 dst_sel:DWORD dst_unused:UNUSED_PAD src0_sel:WORD_0 src1_sel:WORD_0
    ds_read_b32 v234, v4
    v_add_u32_sdwa v19, v80, v19 dst_sel:DWORD dst_unused:UNUSED_PAD src0_sel:WORD_0 src1_sel:WORD_1
    ds_read_b32 v235, v19
    v_add_u32_sdwa v16, v80, v16 dst_sel:DWORD dst_unused:UNUSED_PAD src0_sel:WORD_0 src1_sel:WORD_1
    ds_read_b32 v236, v16
    v_lshrrev_b32 v112, 2, v86
    v_bfe_i32 v116, v86, v248, 1
    v_and_b32 v112, v112, v198
    v_and_b32 v120, v116, v249
    v_add3_u32 v112, v112, v247, v120
    v_and_b32 v116, v116, v246
    buffer_load_dwordx4 v[40:43], v112, s[20:23], s32 offen sc1
    v_and_or_b32 v86, v86, 12, v116
    s_waitcnt vmcnt(5)
    v_and_b32 v20, v20, v81
    v_add_u32_sdwa v2, v81, v21 dst_sel:DWORD dst_unused:UNUSED_PAD src0_sel:WORD_0 src1_sel:WORD_0
    ds_read_b32 v238, v2
    v_add_u32_sdwa v21, v81, v21 dst_sel:DWORD dst_unused:UNUSED_PAD src0_sel:WORD_0 src1_sel:WORD_1
    ds_read_b32 v239, v21
    v_add_u32_sdwa v3, v81, v22 dst_sel:DWORD dst_unused:UNUSED_PAD src0_sel:WORD_0 src1_sel:WORD_0
    ds_read_b32 v240, v3
    v_add_u32_sdwa v22, v81, v22 dst_sel:DWORD dst_unused:UNUSED_PAD src0_sel:WORD_0 src1_sel:WORD_1
    ds_read_b32 v241, v22
    v_add_u32_sdwa v4, v81, v23 dst_sel:DWORD dst_unused:UNUSED_PAD src0_sel:WORD_0 src1_sel:WORD_0
    ds_read_b32 v242, v4
    v_add_u32_sdwa v23, v81, v23 dst_sel:DWORD dst_unused:UNUSED_PAD src0_sel:WORD_0 src1_sel:WORD_1
    ds_read_b32 v243, v23
    v_add_u32_sdwa v20, v81, v20 dst_sel:DWORD dst_unused:UNUSED_PAD src0_sel:WORD_0 src1_sel:WORD_1
    ds_read_b32 v244, v20
    s_waitcnt lgkmcnt(7)
    v_mfma_f32_16x16x32_bf16 v[182:185], v[166:169], v[230:233], 0
    v_mfma_f32_16x16x32_bf16 v[182:185], v[166:169], v[234:237], v[182:185]
    v_lshrrev_b32 v112, 2, v87
    v_bfe_i32 v116, v87, v248, 1
    v_and_b32 v112, v112, v198
    v_and_b32 v120, v116, v249
    v_add3_u32 v112, v112, v247, v120
    v_and_b32 v116, v116, v246
    buffer_load_dwordx4 v[44:47], v112, s[20:23], s32 offen sc1
    v_and_or_b32 v87, v87, 12, v116
    s_waitcnt vmcnt(5)
    v_and_b32 v24, v24, v82
    v_add_u32_sdwa v2, v82, v25 dst_sel:DWORD dst_unused:UNUSED_PAD src0_sel:WORD_0 src1_sel:WORD_0
    ds_read_b32 v230, v2
    v_add_u32_sdwa v25, v82, v25 dst_sel:DWORD dst_unused:UNUSED_PAD src0_sel:WORD_0 src1_sel:WORD_1
    ds_read_b32 v231, v25
    v_add_u32_sdwa v3, v82, v26 dst_sel:DWORD dst_unused:UNUSED_PAD src0_sel:WORD_0 src1_sel:WORD_0
    ds_read_b32 v232, v3
    v_add_u32_sdwa v26, v82, v26 dst_sel:DWORD dst_unused:UNUSED_PAD src0_sel:WORD_0 src1_sel:WORD_1
    ds_read_b32 v233, v26
    v_add_u32_sdwa v4, v82, v27 dst_sel:DWORD dst_unused:UNUSED_PAD src0_sel:WORD_0 src1_sel:WORD_0
    ds_read_b32 v234, v4
    v_add_u32_sdwa v27, v82, v27 dst_sel:DWORD dst_unused:UNUSED_PAD src0_sel:WORD_0 src1_sel:WORD_1
    ds_read_b32 v235, v27
    v_add_u32_sdwa v24, v82, v24 dst_sel:DWORD dst_unused:UNUSED_PAD src0_sel:WORD_0 src1_sel:WORD_1
    ds_read_b32 v236, v24
    s_waitcnt lgkmcnt(7)
    v_mfma_f32_16x16x32_bf16 v[182:185], v[170:173], v[238:241], v[182:185]
    v_mfma_f32_16x16x32_bf16 v[182:185], v[170:173], v[242:245], v[182:185]
    v_lshrrev_b32 v112, 2, v88
    v_bfe_i32 v116, v88, v248, 1
    v_and_b32 v112, v112, v198
    v_and_b32 v120, v116, v249
    v_add3_u32 v112, v112, v247, v120
    v_and_b32 v116, v116, v246
    buffer_load_dwordx4 v[48:51], v112, s[20:23], s32 offen sc1
    v_and_or_b32 v88, v88, 12, v116
    s_waitcnt vmcnt(5)
    v_and_b32 v28, v28, v83
    v_add_u32_sdwa v2, v83, v29 dst_sel:DWORD dst_unused:UNUSED_PAD src0_sel:WORD_0 src1_sel:WORD_0
    ds_read_b32 v238, v2
    v_add_u32_sdwa v29, v83, v29 dst_sel:DWORD dst_unused:UNUSED_PAD src0_sel:WORD_0 src1_sel:WORD_1
    ds_read_b32 v239, v29
    v_add_u32_sdwa v3, v83, v30 dst_sel:DWORD dst_unused:UNUSED_PAD src0_sel:WORD_0 src1_sel:WORD_0
    ds_read_b32 v240, v3
    v_add_u32_sdwa v30, v83, v30 dst_sel:DWORD dst_unused:UNUSED_PAD src0_sel:WORD_0 src1_sel:WORD_1
    ds_read_b32 v241, v30
    v_add_u32_sdwa v4, v83, v31 dst_sel:DWORD dst_unused:UNUSED_PAD src0_sel:WORD_0 src1_sel:WORD_0
    ds_read_b32 v242, v4
    v_add_u32_sdwa v31, v83, v31 dst_sel:DWORD dst_unused:UNUSED_PAD src0_sel:WORD_0 src1_sel:WORD_1
    ds_read_b32 v243, v31
    v_add_u32_sdwa v28, v83, v28 dst_sel:DWORD dst_unused:UNUSED_PAD src0_sel:WORD_0 src1_sel:WORD_1
    ds_read_b32 v244, v28
    s_waitcnt lgkmcnt(7)
    v_mfma_f32_16x16x32_bf16 v[182:185], v[174:177], v[230:233], v[182:185]
    v_mfma_f32_16x16x32_bf16 v[182:185], v[174:177], v[234:237], v[182:185]
    v_lshrrev_b32 v112, 2, v89
    v_bfe_i32 v116, v89, v248, 1
    v_and_b32 v112, v112, v198
    v_and_b32 v120, v116, v249
    v_add3_u32 v112, v112, v247, v120
    v_and_b32 v116, v116, v246
    buffer_load_dwordx4 v[52:55], v112, s[20:23], s32 offen sc1
    v_and_or_b32 v89, v89, 12, v116
    s_waitcnt vmcnt(5)
    v_and_b32 v32, v32, v84
    v_add_u32_sdwa v2, v84, v33 dst_sel:DWORD dst_unused:UNUSED_PAD src0_sel:WORD_0 src1_sel:WORD_0
    ds_read_b32 v230, v2
    v_add_u32_sdwa v33, v84, v33 dst_sel:DWORD dst_unused:UNUSED_PAD src0_sel:WORD_0 src1_sel:WORD_1
    ds_read_b32 v231, v33
    v_add_u32_sdwa v3, v84, v34 dst_sel:DWORD dst_unused:UNUSED_PAD src0_sel:WORD_0 src1_sel:WORD_0
    ds_read_b32 v232, v3
    v_add_u32_sdwa v34, v84, v34 dst_sel:DWORD dst_unused:UNUSED_PAD src0_sel:WORD_0 src1_sel:WORD_1
    ds_read_b32 v233, v34
    v_add_u32_sdwa v4, v84, v35 dst_sel:DWORD dst_unused:UNUSED_PAD src0_sel:WORD_0 src1_sel:WORD_0
    ds_read_b32 v234, v4
    v_add_u32_sdwa v35, v84, v35 dst_sel:DWORD dst_unused:UNUSED_PAD src0_sel:WORD_0 src1_sel:WORD_1
    ds_read_b32 v235, v35
    v_add_u32_sdwa v32, v84, v32 dst_sel:DWORD dst_unused:UNUSED_PAD src0_sel:WORD_0 src1_sel:WORD_1
    ds_read_b32 v236, v32
    s_waitcnt lgkmcnt(7)
    v_mfma_f32_16x16x32_bf16 v[182:185], v[178:181], v[238:241], v[182:185]
    v_mfma_f32_16x16x32_bf16 v[182:185], v[178:181], v[242:245], v[182:185]
    v_lshrrev_b32 v112, 2, v90
    v_bfe_i32 v116, v90, v248, 1
    v_and_b32 v112, v112, v198
    v_and_b32 v120, v116, v249
    v_add3_u32 v112, v112, v247, v120
    v_and_b32 v116, v116, v246
    buffer_load_dwordx4 v[56:59], v112, s[20:23], s32 offen sc1
    v_and_or_b32 v90, v90, 12, v116
    s_waitcnt vmcnt(5)
    v_and_b32 v36, v36, v85
    v_add_u32_sdwa v2, v85, v37 dst_sel:DWORD dst_unused:UNUSED_PAD src0_sel:WORD_0 src1_sel:WORD_0
    ds_read_b32 v238, v2
    v_add_u32_sdwa v37, v85, v37 dst_sel:DWORD dst_unused:UNUSED_PAD src0_sel:WORD_0 src1_sel:WORD_1
    ds_read_b32 v239, v37
    v_add_u32_sdwa v3, v85, v38 dst_sel:DWORD dst_unused:UNUSED_PAD src0_sel:WORD_0 src1_sel:WORD_0
    ds_read_b32 v240, v3
    v_add_u32_sdwa v38, v85, v38 dst_sel:DWORD dst_unused:UNUSED_PAD src0_sel:WORD_0 src1_sel:WORD_1
    ds_read_b32 v241, v38
    v_add_u32_sdwa v4, v85, v39 dst_sel:DWORD dst_unused:UNUSED_PAD src0_sel:WORD_0 src1_sel:WORD_0
    ds_read_b32 v242, v4
    v_add_u32_sdwa v39, v85, v39 dst_sel:DWORD dst_unused:UNUSED_PAD src0_sel:WORD_0 src1_sel:WORD_1
    ds_read_b32 v243, v39
    v_add_u32_sdwa v36, v85, v36 dst_sel:DWORD dst_unused:UNUSED_PAD src0_sel:WORD_0 src1_sel:WORD_1
    ds_read_b32 v244, v36
    s_waitcnt lgkmcnt(7)
    v_mfma_f32_16x16x32_bf16 v[186:189], v[166:169], v[230:233], 0
    v_mfma_f32_16x16x32_bf16 v[186:189], v[166:169], v[234:237], v[186:189]
    v_lshrrev_b32 v112, 2, v91
    v_bfe_i32 v116, v91, v248, 1
    v_and_b32 v112, v112, v198
    v_and_b32 v120, v116, v249
    v_add3_u32 v112, v112, v247, v120
    v_and_b32 v116, v116, v246
    buffer_load_dwordx4 v[60:63], v112, s[20:23], s32 offen sc1
    v_and_or_b32 v91, v91, 12, v116
    v_cvt_pk_bf16_f32 v182, v183, v182
    v_cvt_pk_bf16_f32 v184, v185, v184
    ds_write_b32 v202, v182
    ds_write_b32 v203, v184
    s_waitcnt vmcnt(5)
    v_and_b32 v40, v40, v86
    v_add_u32_sdwa v2, v86, v41 dst_sel:DWORD dst_unused:UNUSED_PAD src0_sel:WORD_0 src1_sel:WORD_0
    ds_read_b32 v230, v2
    v_add_u32_sdwa v41, v86, v41 dst_sel:DWORD dst_unused:UNUSED_PAD src0_sel:WORD_0 src1_sel:WORD_1
    ds_read_b32 v231, v41
    v_add_u32_sdwa v3, v86, v42 dst_sel:DWORD dst_unused:UNUSED_PAD src0_sel:WORD_0 src1_sel:WORD_0
    ds_read_b32 v232, v3
    v_add_u32_sdwa v42, v86, v42 dst_sel:DWORD dst_unused:UNUSED_PAD src0_sel:WORD_0 src1_sel:WORD_1
    ds_read_b32 v233, v42
    v_add_u32_sdwa v4, v86, v43 dst_sel:DWORD dst_unused:UNUSED_PAD src0_sel:WORD_0 src1_sel:WORD_0
    ds_read_b32 v234, v4
    v_add_u32_sdwa v43, v86, v43 dst_sel:DWORD dst_unused:UNUSED_PAD src0_sel:WORD_0 src1_sel:WORD_1
    ds_read_b32 v235, v43
    v_add_u32_sdwa v40, v86, v40 dst_sel:DWORD dst_unused:UNUSED_PAD src0_sel:WORD_0 src1_sel:WORD_1
    ds_read_b32 v236, v40
    s_waitcnt lgkmcnt(7)
    v_mfma_f32_16x16x32_bf16 v[186:189], v[170:173], v[238:241], v[186:189]
    v_mfma_f32_16x16x32_bf16 v[186:189], v[170:173], v[242:245], v[186:189]
    v_lshrrev_b32 v112, 2, v92
    v_bfe_i32 v116, v92, v248, 1
    v_and_b32 v112, v112, v198
    v_and_b32 v120, v116, v249
    v_add3_u32 v112, v112, v247, v120
    v_and_b32 v116, v116, v246
    buffer_load_dwordx4 v[64:67], v112, s[20:23], s32 offen sc1
    v_and_or_b32 v92, v92, 12, v116
    s_waitcnt vmcnt(5)
    v_and_b32 v44, v44, v87
    v_add_u32_sdwa v2, v87, v45 dst_sel:DWORD dst_unused:UNUSED_PAD src0_sel:WORD_0 src1_sel:WORD_0
    ds_read_b32 v238, v2
    v_add_u32_sdwa v45, v87, v45 dst_sel:DWORD dst_unused:UNUSED_PAD src0_sel:WORD_0 src1_sel:WORD_1
    ds_read_b32 v239, v45
    v_add_u32_sdwa v3, v87, v46 dst_sel:DWORD dst_unused:UNUSED_PAD src0_sel:WORD_0 src1_sel:WORD_0
    ds_read_b32 v240, v3
    v_add_u32_sdwa v46, v87, v46 dst_sel:DWORD dst_unused:UNUSED_PAD src0_sel:WORD_0 src1_sel:WORD_1
    ds_read_b32 v241, v46
    v_add_u32_sdwa v4, v87, v47 dst_sel:DWORD dst_unused:UNUSED_PAD src0_sel:WORD_0 src1_sel:WORD_0
    ds_read_b32 v242, v4
    v_add_u32_sdwa v47, v87, v47 dst_sel:DWORD dst_unused:UNUSED_PAD src0_sel:WORD_0 src1_sel:WORD_1
    ds_read_b32 v243, v47
    v_add_u32_sdwa v44, v87, v44 dst_sel:DWORD dst_unused:UNUSED_PAD src0_sel:WORD_0 src1_sel:WORD_1
    ds_read_b32 v244, v44
    s_waitcnt lgkmcnt(7)
    v_mfma_f32_16x16x32_bf16 v[186:189], v[174:177], v[230:233], v[186:189]
    v_mfma_f32_16x16x32_bf16 v[186:189], v[174:177], v[234:237], v[186:189]
    v_lshrrev_b32 v112, 2, v93
    v_bfe_i32 v116, v93, v248, 1
    v_and_b32 v112, v112, v198
    v_and_b32 v120, v116, v249
    v_add3_u32 v112, v112, v247, v120
    v_and_b32 v116, v116, v246
    buffer_load_dwordx4 v[68:71], v112, s[20:23], s32 offen sc1
    v_and_or_b32 v93, v93, 12, v116
    s_waitcnt vmcnt(5)
    v_and_b32 v48, v48, v88
    v_add_u32_sdwa v2, v88, v49 dst_sel:DWORD dst_unused:UNUSED_PAD src0_sel:WORD_0 src1_sel:WORD_0
    ds_read_b32 v230, v2
    v_add_u32_sdwa v49, v88, v49 dst_sel:DWORD dst_unused:UNUSED_PAD src0_sel:WORD_0 src1_sel:WORD_1
    ds_read_b32 v231, v49
    v_add_u32_sdwa v3, v88, v50 dst_sel:DWORD dst_unused:UNUSED_PAD src0_sel:WORD_0 src1_sel:WORD_0
    ds_read_b32 v232, v3
    v_add_u32_sdwa v50, v88, v50 dst_sel:DWORD dst_unused:UNUSED_PAD src0_sel:WORD_0 src1_sel:WORD_1
    ds_read_b32 v233, v50
    v_add_u32_sdwa v4, v88, v51 dst_sel:DWORD dst_unused:UNUSED_PAD src0_sel:WORD_0 src1_sel:WORD_0
    ds_read_b32 v234, v4
    v_add_u32_sdwa v51, v88, v51 dst_sel:DWORD dst_unused:UNUSED_PAD src0_sel:WORD_0 src1_sel:WORD_1
    ds_read_b32 v235, v51
    v_add_u32_sdwa v48, v88, v48 dst_sel:DWORD dst_unused:UNUSED_PAD src0_sel:WORD_0 src1_sel:WORD_1
    ds_read_b32 v236, v48
    s_waitcnt lgkmcnt(7)
    v_mfma_f32_16x16x32_bf16 v[186:189], v[178:181], v[238:241], v[186:189]
    v_mfma_f32_16x16x32_bf16 v[186:189], v[178:181], v[242:245], v[186:189]
    v_lshrrev_b32 v112, 2, v94
    v_bfe_i32 v116, v94, v248, 1
    v_and_b32 v112, v112, v198
    v_and_b32 v120, v116, v249
    v_add3_u32 v112, v112, v247, v120
    v_and_b32 v116, v116, v246
    buffer_load_dwordx4 v[72:75], v112, s[20:23], s32 offen sc1
    v_and_or_b32 v94, v94, 12, v116
    s_waitcnt vmcnt(5)
    v_and_b32 v52, v52, v89
    v_add_u32_sdwa v2, v89, v53 dst_sel:DWORD dst_unused:UNUSED_PAD src0_sel:WORD_0 src1_sel:WORD_0
    ds_read_b32 v238, v2
    v_add_u32_sdwa v53, v89, v53 dst_sel:DWORD dst_unused:UNUSED_PAD src0_sel:WORD_0 src1_sel:WORD_1
    ds_read_b32 v239, v53
    v_add_u32_sdwa v3, v89, v54 dst_sel:DWORD dst_unused:UNUSED_PAD src0_sel:WORD_0 src1_sel:WORD_0
    ds_read_b32 v240, v3
    v_add_u32_sdwa v54, v89, v54 dst_sel:DWORD dst_unused:UNUSED_PAD src0_sel:WORD_0 src1_sel:WORD_1
    ds_read_b32 v241, v54
    v_add_u32_sdwa v4, v89, v55 dst_sel:DWORD dst_unused:UNUSED_PAD src0_sel:WORD_0 src1_sel:WORD_0
    ds_read_b32 v242, v4
    v_add_u32_sdwa v55, v89, v55 dst_sel:DWORD dst_unused:UNUSED_PAD src0_sel:WORD_0 src1_sel:WORD_1
    ds_read_b32 v243, v55
    v_add_u32_sdwa v52, v89, v52 dst_sel:DWORD dst_unused:UNUSED_PAD src0_sel:WORD_0 src1_sel:WORD_1
    ds_read_b32 v244, v52
    s_waitcnt lgkmcnt(7)
    v_mfma_f32_16x16x32_bf16 v[190:193], v[166:169], v[230:233], 0
    v_mfma_f32_16x16x32_bf16 v[190:193], v[166:169], v[234:237], v[190:193]
    v_lshrrev_b32 v112, 2, v95
    v_bfe_i32 v116, v95, v248, 1
    v_and_b32 v112, v112, v198
    v_and_b32 v120, v116, v249
    v_add3_u32 v112, v112, v247, v120
    v_and_b32 v116, v116, v246
    buffer_load_dwordx4 v[76:79], v112, s[20:23], s32 offen sc1
    v_and_or_b32 v95, v95, 12, v116
    v_cvt_pk_bf16_f32 v186, v187, v186
    v_cvt_pk_bf16_f32 v188, v189, v188
    ds_write_b32 v204, v186
    ds_write_b32 v205, v188
    ds_read2st64_b32 v[16:17], v200 offset0:0 offset1:1
    ds_read2st64_b32 v[18:19], v200 offset0:2 offset1:3
    s_waitcnt vmcnt(5)
    v_and_b32 v56, v56, v90
    v_add_u32_sdwa v2, v90, v57 dst_sel:DWORD dst_unused:UNUSED_PAD src0_sel:WORD_0 src1_sel:WORD_0
    ds_read_b32 v230, v2
    v_add_u32_sdwa v57, v90, v57 dst_sel:DWORD dst_unused:UNUSED_PAD src0_sel:WORD_0 src1_sel:WORD_1
    ds_read_b32 v231, v57
    v_add_u32_sdwa v3, v90, v58 dst_sel:DWORD dst_unused:UNUSED_PAD src0_sel:WORD_0 src1_sel:WORD_0
    ds_read_b32 v232, v3
    v_add_u32_sdwa v58, v90, v58 dst_sel:DWORD dst_unused:UNUSED_PAD src0_sel:WORD_0 src1_sel:WORD_1
    ds_read_b32 v233, v58
    v_add_u32_sdwa v4, v90, v59 dst_sel:DWORD dst_unused:UNUSED_PAD src0_sel:WORD_0 src1_sel:WORD_0
    ds_read_b32 v234, v4
    v_add_u32_sdwa v59, v90, v59 dst_sel:DWORD dst_unused:UNUSED_PAD src0_sel:WORD_0 src1_sel:WORD_1
    ds_read_b32 v235, v59
    v_add_u32_sdwa v56, v90, v56 dst_sel:DWORD dst_unused:UNUSED_PAD src0_sel:WORD_0 src1_sel:WORD_1
    ds_read_b32 v236, v56
    s_waitcnt lgkmcnt(7)
    v_mfma_f32_16x16x32_bf16 v[190:193], v[170:173], v[238:241], v[190:193]
    v_mfma_f32_16x16x32_bf16 v[190:193], v[170:173], v[242:245], v[190:193]
    s_bitcmp1_b32 s3, 0
    s_cbranch_scc0 L_ea
    v_and_or_b32 v16, v16, v251, v252
    v_and_or_b32 v17, v17, v251, v253
    v_and_or_b32 v18, v18, v251, v254
    v_and_or_b32 v19, v19, v251, v255
    s_add_u32 s56, s35, 0x0
    buffer_store_dwordx4 v[16:19], v201, s[24:27], s56 offen sc1
    s_bitset1_b32 s61, 0
L_ea:
    s_waitcnt vmcnt(4)
    v_and_b32 v60, v60, v91
    v_add_u32_sdwa v2, v91, v61 dst_sel:DWORD dst_unused:UNUSED_PAD src0_sel:WORD_0 src1_sel:WORD_0
    ds_read_b32 v238, v2
    v_add_u32_sdwa v61, v91, v61 dst_sel:DWORD dst_unused:UNUSED_PAD src0_sel:WORD_0 src1_sel:WORD_1
    ds_read_b32 v239, v61
    v_add_u32_sdwa v3, v91, v62 dst_sel:DWORD dst_unused:UNUSED_PAD src0_sel:WORD_0 src1_sel:WORD_0
    ds_read_b32 v240, v3
    v_add_u32_sdwa v62, v91, v62 dst_sel:DWORD dst_unused:UNUSED_PAD src0_sel:WORD_0 src1_sel:WORD_1
    ds_read_b32 v241, v62
    v_add_u32_sdwa v4, v91, v63 dst_sel:DWORD dst_unused:UNUSED_PAD src0_sel:WORD_0 src1_sel:WORD_0
    ds_read_b32 v242, v4
    v_add_u32_sdwa v63, v91, v63 dst_sel:DWORD dst_unused:UNUSED_PAD src0_sel:WORD_0 src1_sel:WORD_1
    ds_read_b32 v243, v63
    v_add_u32_sdwa v60, v91, v60 dst_sel:DWORD dst_unused:UNUSED_PAD src0_sel:WORD_0 src1_sel:WORD_1
    ds_read_b32 v244, v60
    s_waitcnt lgkmcnt(7)
    v_mfma_f32_16x16x32_bf16 v[190:193], v[174:177], v[230:233], v[190:193]
    v_mfma_f32_16x16x32_bf16 v[190:193], v[174:177], v[234:237], v[190:193]
    s_cmp_le_u32 s55, 12
    s_cbranch_scc1 L_x11
    s_waitcnt vmcnt(3)
    v_and_b32 v64, v64, v92
    v_add_u32_sdwa v2, v92, v65 dst_sel:DWORD dst_unused:UNUSED_PAD src0_sel:WORD_0 src1_sel:WORD_0
    ds_read_b32 v230, v2
    v_add_u32_sdwa v65, v92, v65 dst_sel:DWORD dst_unused:UNUSED_PAD src0_sel:WORD_0 src1_sel:WORD_1
    ds_read_b32 v231, v65
    v_add_u32_sdwa v3, v92, v66 dst_sel:DWORD dst_unused:UNUSED_PAD src0_sel:WORD_0 src1_sel:WORD_0
    ds_read_b32 v232, v3
    v_add_u32_sdwa v66, v92, v66 dst_sel:DWORD dst_unused:UNUSED_PAD src0_sel:WORD_0 src1_sel:WORD_1
    ds_read_b32 v233, v66
    v_add_u32_sdwa v4, v92, v67 dst_sel:DWORD dst_unused:UNUSED_PAD src0_sel:WORD_0 src1_sel:WORD_0
    ds_read_b32 v234, v4
    v_add_u32_sdwa v67, v92, v67 dst_sel:DWORD dst_unused:UNUSED_PAD src0_sel:WORD_0 src1_sel:WORD_1
    ds_read_b32 v235, v67
    v_add_u32_sdwa v64, v92, v64 dst_sel:DWORD dst_unused:UNUSED_PAD src0_sel:WORD_0 src1_sel:WORD_1
    ds_read_b32 v236, v64
    s_waitcnt lgkmcnt(7)
    v_mfma_f32_16x16x32_bf16 v[190:193], v[178:181], v[238:241], v[190:193]
    v_mfma_f32_16x16x32_bf16 v[190:193], v[178:181], v[242:245], v[190:193]
    s_cmp_le_u32 s55, 13
    s_cbranch_scc1 L_x12
    s_waitcnt vmcnt(2)
    v_and_b32 v68, v68, v93
    v_add_u32_sdwa v2, v93, v69 dst_sel:DWORD dst_unused:UNUSED_PAD src0_sel:WORD_0 src1_sel:WORD_0
    ds_read_b32 v238, v2
    v_add_u32_sdwa v69, v93, v69 dst_sel:DWORD dst_unused:UNUSED_PAD src0_sel:WORD_0 src1_sel:WORD_1
    ds_read_b32 v239, v69
    v_add_u32_sdwa v3, v93, v70 dst_sel:DWORD dst_unused:UNUSED_PAD src0_sel:WORD_0 src1_sel:WORD_0
    ds_read_b32 v240, v3
    v_add_u32_sdwa v70, v93, v70 dst_sel:DWORD dst_unused:UNUSED_PAD src0_sel:WORD_0 src1_sel:WORD_1
    ds_read_b32 v241, v70
    v_add_u32_sdwa v4, v93, v71 dst_sel:DWORD dst_unused:UNUSED_PAD src0_sel:WORD_0 src1_sel:WORD_0
    ds_read_b32 v242, v4
    v_add_u32_sdwa v71, v93, v71 dst_sel:DWORD dst_unused:UNUSED_PAD src0_sel:WORD_0 src1_sel:WORD_1
    ds_read_b32 v243, v71
    v_add_u32_sdwa v68, v93, v68 dst_sel:DWORD dst_unused:UNUSED_PAD src0_sel:WORD_0 src1_sel:WORD_1
    ds_read_b32 v244, v68
    s_waitcnt lgkmcnt(7)
    v_mfma_f32_16x16x32_bf16 v[194:197], v[166:169], v[230:233], 0
    v_mfma_f32_16x16x32_bf16 v[194:197], v[166:169], v[234:237], v[194:197]
    v_cvt_pk_bf16_f32 v190, v191, v190
    v_cvt_pk_bf16_f32 v192, v193, v192
    ds_write_b32 v206, v190
    ds_write_b32 v207, v192
    ds_read2st64_b32 v[20:21], v214 offset0:0 offset1:1
    ds_read2st64_b32 v[22:23], v214 offset0:2 offset1:3
    ds_read2st64_b32 v[24:25], v215 offset0:0 offset1:1
    ds_read2st64_b32 v[26:27], v215 offset0:2 offset1:3
    s_cmp_le_u32 s55, 14
    s_cbranch_scc1 L_x13
    s_waitcnt vmcnt(1)
    v_and_b32 v72, v72, v94
    v_add_u32_sdwa v2, v94, v73 dst_sel:DWORD dst_unused:UNUSED_PAD src0_sel:WORD_0 src1_sel:WORD_0
    ds_read_b32 v230, v2
    v_add_u32_sdwa v73, v94, v73 dst_sel:DWORD dst_unused:UNUSED_PAD src0_sel:WORD_0 src1_sel:WORD_1
    ds_read_b32 v231, v73
    v_add_u32_sdwa v3, v94, v74 dst_sel:DWORD dst_unused:UNUSED_PAD src0_sel:WORD_0 src1_sel:WORD_0
    ds_read_b32 v232, v3
    v_add_u32_sdwa v74, v94, v74 dst_sel:DWORD dst_unused:UNUSED_PAD src0_sel:WORD_0 src1_sel:WORD_1
    ds_read_b32 v233, v74
    v_add_u32_sdwa v4, v94, v75 dst_sel:DWORD dst_unused:UNUSED_PAD src0_sel:WORD_0 src1_sel:WORD_0
    ds_read_b32 v234, v4
    v_add_u32_sdwa v75, v94, v75 dst_sel:DWORD dst_unused:UNUSED_PAD src0_sel:WORD_0 src1_sel:WORD_1
    ds_read_b32 v235, v75
    v_add_u32_sdwa v72, v94, v72 dst_sel:DWORD dst_unused:UNUSED_PAD src0_sel:WORD_0 src1_sel:WORD_1
    ds_read_b32 v236, v72
    s_waitcnt lgkmcnt(7)
    v_mfma_f32_16x16x32_bf16 v[194:197], v[170:173], v[238:241], v[194:197]
    v_mfma_f32_16x16x32_bf16 v[194:197], v[170:173], v[242:245], v[194:197]
    s_bitcmp1_b32 s3, 1
    s_cbranch_scc0 L_eb
    v_and_or_b32 v20, v20, v251, v252
    v_and_or_b32 v21, v21, v251, v253
    v_and_or_b32 v22, v22, v251, v254
    v_and_or_b32 v23, v23, v251, v255
    s_add_u32 s56, s35, 0x40000
    buffer_store_dwordx4 v[20:23], v201, s[24:27], s56 offen sc1
    s_bitset1_b32 s61, 1
L_eb:
    s_bitcmp1_b32 s3, 2
    s_cbranch_scc0 L_ec
    v_and_or_b32 v24, v24, v251, v252
    v_and_or_b32 v25, v25, v251, v253
    v_and_or_b32 v26, v26, v251, v254
    v_and_or_b32 v27, v27, v251, v255
    s_add_u32 s56, s35, 0x80000
    buffer_store_dwordx4 v[24:27], v201, s[24:27], s56 offen sc1
    s_bitset1_b32 s61, 2
L_ec:
    s_cmp_le_u32 s55, 15
    s_cbranch_scc1 L_x14
    s_waitcnt vmcnt(0)
    v_and_b32 v76, v76, v95
    v_add_u32_sdwa v2, v95, v77 dst_sel:DWORD dst_unused:UNUSED_PAD src0_sel:WORD_0 src1_sel:WORD_0
    ds_read_b32 v238, v2
    v_add_u32_sdwa v77, v95, v77 dst_sel:DWORD dst_unused:UNUSED_PAD src0_sel:WORD_0 src1_sel:WORD_1
    ds_read_b32 v239, v77
    v_add_u32_sdwa v3, v95, v78 dst_sel:DWORD dst_unused:UNUSED_PAD src0_sel:WORD_0 src1_sel:WORD_0
    ds_read_b32 v240, v3
    v_add_u32_sdwa v78, v95, v78 dst_sel:DWORD dst_unused:UNUSED_PAD src0_sel:WORD_0 src1_sel:WORD_1
    ds_read_b32 v241, v78
    v_add_u32_sdwa v4, v95, v79 dst_sel:DWORD dst_unused:UNUSED_PAD src0_sel:WORD_0 src1_sel:WORD_0
    ds_read_b32 v242, v4
    v_add_u32_sdwa v79, v95, v79 dst_sel:DWORD dst_unused:UNUSED_PAD src0_sel:WORD_0 src1_sel:WORD_1
    ds_read_b32 v243, v79
    v_add_u32_sdwa v76, v95, v76 dst_sel:DWORD dst_unused:UNUSED_PAD src0_sel:WORD_0 src1_sel:WORD_1
    ds_read_b32 v244, v76
    s_waitcnt lgkmcnt(7)
    v_mfma_f32_16x16x32_bf16 v[194:197], v[174:177], v[230:233], v[194:197]
    v_mfma_f32_16x16x32_bf16 v[194:197], v[174:177], v[234:237], v[194:197]
    s_waitcnt lgkmcnt(0)
    v_mfma_f32_16x16x32_bf16 v[194:197], v[178:181], v[238:241], v[194:197]
    v_mfma_f32_16x16x32_bf16 v[194:197], v[178:181], v[242:245], v[194:197]
    s_nop 6
    s_branch L_tiles_done
L_x11:
    s_waitcnt lgkmcnt(0)
    v_mfma_f32_16x16x32_bf16 v[190:193], v[178:181], v[238:241], v[190:193]
    v_mfma_f32_16x16x32_bf16 v[190:193], v[178:181], v[242:245], v[190:193]
    s_nop 7
    v_cvt_pk_bf16_f32 v190, v191, v190
    v_cvt_pk_bf16_f32 v192, v193, v192
    ds_write_b32 v206, v190
    ds_write_b32 v207, v192
    s_branch L_tiles_done
L_x12:
    s_waitcnt lgkmcnt(0)
    v_mfma_f32_16x16x32_bf16 v[194:197], v[166:169], v[230:233], 0
    v_mfma_f32_16x16x32_bf16 v[194:197], v[166:169], v[234:237], v[194:197]
    s_nop 7
    v_cvt_pk_bf16_f32 v190, v191, v190
    v_cvt_pk_bf16_f32 v192, v193, v192
    ds_write_b32 v206, v190
    ds_write_b32 v207, v192
    s_branch L_tiles_done
L_x14:
    s_waitcnt lgkmcnt(0)
    v_mfma_f32_16x16x32_bf16 v[194:197], v[174:177], v[230:233], v[194:197]
    v_mfma_f32_16x16x32_bf16 v[194:197], v[174:177], v[234:237], v[194:197]
    s_nop 6
    s_branch L_tiles_done
L_x13:
    s_waitcnt lgkmcnt(0)
    v_mfma_f32_16x16x32_bf16 v[194:197], v[170:173], v[238:241], v[194:197]
    v_mfma_f32_16x16x32_bf16 v[194:197], v[170:173], v[242:245], v[194:197]
    s_bitcmp1_b32 s3, 1
    s_cbranch_scc0 L_ed
    v_and_or_b32 v20, v20, v251, v252
    v_and_or_b32 v21, v21, v251, v253
    v_and_or_b32 v22, v22, v251, v254
    v_and_or_b32 v23, v23, v251, v255
    s_add_u32 s56, s35, 0x40000
    buffer_store_dwordx4 v[20:23], v201, s[24:27], s56 offen sc1
    s_bitset1_b32 s61, 1
L_ed:
    s_bitcmp1_b32 s3, 2
    s_cbranch_scc0 L_ee
    v_and_or_b32 v24, v24, v251, v252
    v_and_or_b32 v25, v25, v251, v253
    v_and_or_b32 v26, v26, v251, v254
    v_and_or_b32 v27, v27, v251, v255
    s_add_u32 s56, s35, 0x80000
    buffer_store_dwordx4 v[24:27], v201, s[24:27], s56 offen sc1
    s_bitset1_b32 s61, 2
L_ee:
    s_nop 3
L_tiles_done:
    v_cvt_pk_bf16_f32 v194, v195, v194
    v_cvt_pk_bf16_f32 v196, v197, v196
    ds_write_b32 v208, v194
    ds_write_b32 v209, v196
    s_cmp_gt_u32 s58, 512
    s_cbranch_scc1 L_more
    ds_read2st64_b32 v[28:29], v216 offset0:0 offset1:1
    ds_read2st64_b32 v[30:31], v216 offset0:2 offset1:3
    s_cmp_lg_u32 s61, 7
    s_cbranch_scc1 L_late
L_late_ret:
    s_waitcnt lgkmcnt(0)
    v_and_or_b32 v28, v28, v251, v252
    v_and_or_b32 v29, v29, v251, v253
    v_and_or_b32 v30, v30, v251, v254
    v_and_or_b32 v31, v31, v251, v255
    s_add_u32 s56, s35, 0xc0000
    buffer_store_dwordx4 v[28:31], v201, s[24:27], s56 offen sc1
    s_bitset1_b32 s61, 3
    s_cmp_lg_u32 s59, 0
    s_cbranch_scc1 L_res2
L_res2_ret:
L_nobucket:
    v_mov_b32 v5, 17640
    v_mov_b32 v6, 1
    s_mov_b64 exec, 1
    ds_add_u32 v5, v6
    s_mov_b64 exec, -1
    v_and_b32 v40, 0xffff, v8
    v_and_b32 v41, 0xffff, v9
    v_and_b32 v42, 0xffff, v10
    v_and_b32 v43, 0xffff, v11
    v_and_b32 v44, 0xffff, v12
    v_and_b32 v45, 0xffff, v13
    v_and_b32 v46, 0xffff, v14
    v_and_b32 v47, 0xffff, v15
    s_lshl_b32 s55, s2, 7
    s_lshl_b32 s59, s52, 5
    s_add_u32 s55, s55, s59
    v_lshrrev_b32 v3, 2, v1
    v_lshlrev_b32 v3, 1, v3
    s_waitcnt lgkmcnt(0)
    s_barrier
    s_or_b32 s61, s2, s52
    s_cmp_eq_u32 s61, 0
    s_cbranch_scc1 L_epoch
L_epoch_ret:
    v_mov_b32 v5, 17652
    ds_read_b32 v6, v5
    ds_read_b32 v48, v40
    ds_read_b32 v49, v41
    ds_read_b32 v50, v42
    ds_read_b32 v51, v43
    ds_read_b32 v52, v44
    ds_read_b32 v53, v45
    ds_read_b32 v54, v46
    ds_read_b32 v55, v47
    s_waitcnt lgkmcnt(7)
    v_and_b32 v32, 0x7fff0000, v48
    v_lshlrev_b32 v48, 16, v48
    s_waitcnt lgkmcnt(6)
    v_and_b32 v33, 0x7fff0000, v49
    v_lshlrev_b32 v49, 16, v49
    v_add_f32 v32, v32, v33
    v_add_f32 v48, v48, v49
    s_waitcnt lgkmcnt(5)
    v_and_b32 v34, 0x7fff0000, v50
    v_lshlrev_b32 v50, 16, v50
    s_waitcnt lgkmcnt(4)
    v_and_b32 v35, 0x7fff0000, v51
    v_lshlrev_b32 v51, 16, v51
    v_add_f32 v34, v34, v35
    v_add_f32 v50, v50, v51
    v_add_f32 v32, v32, v34
    v_add_f32 v48, v48, v50
    s_waitcnt lgkmcnt(3)
    v_and_b32 v36, 0x7fff0000, v52
    v_lshlrev_b32 v52, 16, v52
    s_waitcnt lgkmcnt(2)
    v_and_b32 v37, 0x7fff0000, v53
    v_lshlrev_b32 v53, 16, v53
    v_add_f32 v36, v36, v37
    v_add_f32 v52, v52, v53
    s_waitcnt lgkmcnt(1)
    v_and_b32 v38, 0x7fff0000, v54
    v_lshlrev_b32 v54, 16, v54
    s_waitcnt lgkmcnt(0)
    v_and_b32 v39, 0x7fff0000, v55
    v_lshlrev_b32 v55, 16, v55
    v_add_f32 v38, v38, v39
    v_add_f32 v54, v54, v55
    v_add_f32 v36, v36, v38
    v_add_f32 v52, v52, v54
    v_add_f32 v32, v32, v36
    v_add_f32 v48, v48, v52
    s_nop 0
    v_add_f32_dpp v33, v32, v32 quad_perm:[1,0,3,2] row_mask:0xf bank_mask:0xf
    v_add_f32_dpp v49, v48, v48 quad_perm:[1,0,3,2] row_mask:0xf bank_mask:0xf
    s_nop 0
    v_add_f32_dpp v32, v33, v33 quad_perm:[2,3,0,1] row_mask:0xf bank_mask:0xf
    v_add_f32_dpp v48, v49, v49 quad_perm:[2,3,0,1] row_mask:0xf bank_mask:0xf
    v_rcp_f32 v33, v32
    v_add_u32 v34, 0xe8800000, v32
    v_mul_f32 v48, v48, v33
    v_cmp_gt_u32 vcc, 0x5a000000, v34
    v_and_b32 v35, 0x7fffffff, v48
    s_mov_b64 s[62:63], vcc
    v_cmp_gt_u32 vcc, 0x7f800000, v35
    v_cvt_pk_bf16_f32 v48, v48, v48
    s_and_b64 s[62:63], vcc, s[62:63]
    v_cmp_eq_u32 vcc, 0, v6
    s_and_b64 vcc, vcc, s[62:63]
    s_cmp_eq_u64 vcc, -1
    s_cbranch_scc0 L_fallback
    s_mov_b32 exec_lo, 0x11111111
    s_mov_b32 exec_hi, 0x11111111
    buffer_store_short v48, v3, s[28:31], s55 offen
L_fin:
    s_endpgm
L_hi:
    global_load_dwordx4 v[140:143], v5, s[38:39] offset:16
    global_load_short_d16_hi v121, v4, s[40:41] offset:0
    global_load_short_d16_hi v122, v4, s[40:41] offset:64
    global_load_short_d16_hi v123, v4, s[40:41] offset:128
    global_load_short_d16_hi v124, v4, s[40:41] offset:192
    global_load_short_d16_hi v125, v4, s[40:41] offset:256
    global_load_short_d16_hi v126, v4, s[40:41] offset:320
    global_load_short_d16_hi v127, v4, s[40:41] offset:384
    global_load_short_d16_hi v128, v4, s[40:41] offset:448
    global_load_short_d16_hi v129, v4, s[40:41] offset:512
    global_load_short_d16_hi v130, v4, s[40:41] offset:576
    global_load_short_d16_hi v131, v4, s[40:41] offset:640
    global_load_short_d16_hi v132, v4, s[40:41] offset:704
    global_load_short_d16_hi v133, v4, s[40:41] offset:768
    global_load_short_d16_hi v134, v4, s[40:41] offset:832
    global_load_short_d16_hi v135, v4, s[40:41] offset:896
    v_and_b32 v2, 7, v1
    v_lshlrev_b32 v2, 21, v2
    v_add_u32 v2, 0x1fff80, v2
    global_load_dword v255, v2, s[50:51]
    v_mov_b32 v240, -1
    v_mov_b32 v241, -1
    v_mov_b32 v242, -1
    v_mov_b32 v243, -1
    v_lshlrev_b32 v3, 4, v0
    ds_write_b128 v3, v[240:243] offset:32768
    ds_write_b128 v3, v[240:243] offset:40960
    s_and_b32 s60, s52, 3
    s_mov_b64 s[8:9], s[38:39]
    s_mov_b32 s10, 0xfa00
    s_mov_b32 s11, 0x00020000
    v_lshlrev_b32 v7, 6, v6
    v_lshl_add_u32 v250, v252, 5, v7
    v_add_u32 v251, 4096, v250
    s_waitcnt lgkmcnt(0)
    s_load_dword s54, s[50:51], 0x0
    s_barrier
    s_cmp_ge_u32 s2, 250
    s_cbranch_scc1 L_hi_skip
    s_lshl_b32 s32, s60, 14
    s_add_u32 s33, s32, 0x2000
    buffer_load_dwordx4 v[8:11], v250, s[8:11], s32 offen offset:0
    buffer_load_dwordx4 v[12:15], v250, s[8:11], s32 offen offset:16
    buffer_load_dwordx4 v[16:19], v250, s[8:11], s32 offen offset:2048
    buffer_load_dwordx4 v[20:23], v250, s[8:11], s32 offen offset:2064
    s_add_u32 s24, s50, 0x800000
    s_addc_u32 s25, s51, 0
    s_mov_b32 s26, 0x800000
    s_mov_b32 s27, 0x00020000
    s_lshl_b32 s56, s60, 11
    v_lshlrev_b32 v4, 4, v1
    v_add_u32 v5, s56, v4
    v_cmp_gt_u32 vcc, 32, v1
    v_lshlrev_b32 v7, 2, v1
    s_lshl_b32 s56, s60, 12
    v_add_u32 v249, s56, v4
    s_waitcnt vmcnt(5)
    v_lshlrev_b32 v144, 16, v136
    v_and_b32 v145, 0xffff0000, v136
    v_lshlrev_b32 v146, 16, v137
    v_and_b32 v147, 0xffff0000, v137
    v_lshlrev_b32 v148, 16, v138
    v_and_b32 v149, 0xffff0000, v138
    v_lshlrev_b32 v150, 16, v139
    v_and_b32 v151, 0xffff0000, v139
    v_lshlrev_b32 v152, 16, v140
    v_and_b32 v153, 0xffff0000, v140
    v_lshlrev_b32 v154, 16, v141
    v_and_b32 v155, 0xffff0000, v141
    v_lshlrev_b32 v156, 16, v142
    v_and_b32 v157, 0xffff0000, v142
    v_lshlrev_b32 v158, 16, v143
    v_and_b32 v159, 0xffff0000, v143
    v_mul_f32 v120, v120, v144
    v_mul_f32 v121, v121, v145
    v_mul_f32 v122, v122, v146
    v_mul_f32 v123, v123, v147
    v_mul_f32 v124, v124, v148
    v_mul_f32 v125, v125, v149
    v_mul_f32 v126, v126, v150
    v_mul_f32 v127, v127, v151
    v_mul_f32 v128, v128, v152
    v_mul_f32 v129, v129, v153
    v_mul_f32 v130, v130, v154
    v_mul_f32 v131, v131, v155
    v_mul_f32 v132, v132, v156
    v_mul_f32 v133, v133, v157
    v_mul_f32 v134, v134, v158
    v_mul_f32 v135, v135, v159
    v_cvt_pk_bf16_f32 v136, v120, v121
    v_cvt_pk_bf16_f32 v137, v122, v123
    v_cvt_pk_bf16_f32 v138, v124, v125
    v_cvt_pk_bf16_f32 v139, v126, v127
    v_cvt_pk_bf16_f32 v140, v128, v129
    v_cvt_pk_bf16_f32 v141, v130, v131
    v_cvt_pk_bf16_f32 v142, v132, v133
    v_cvt_pk_bf16_f32 v143, v134, v135
    ds_write_b128 v5, v[136:139] offset:20480
    ds_write_b128 v5, v[140:143] offset:21504
    v_mul_f32 v186, 0x3f38aa3b, v186
    v_cndmask_b32 v6, v186, v185, vcc
    ds_write_b32 v7, v6 offset:17664
    buffer_load_dwordx4 v[24:27], v251, s[8:11], s32 offen offset:0
    buffer_load_dwordx4 v[28:31], v251, s[8:11], s32 offen offset:16
    buffer_load_dwordx4 v[32:35], v251, s[8:11], s32 offen offset:2048
    buffer_load_dwordx4 v[36:39], v251, s[8:11], s32 offen offset:2064
    s_waitcnt lgkmcnt(0)
    v_mov_b32 v5, 17644
    v_mov_b32 v6, 1
    s_mov_b64 exec, 1
    ds_add_u32 v5, v6
    s_mov_b64 exec, -1
    v_mov_b32 v5, 17644
L_sync_hi:
    ds_read_b32 v6, v5
    s_waitcnt lgkmcnt(0)
    v_cmp_gt_u32 vcc, 4, v6
    s_cbranch_vccnz L_sync_hi
    v_lshlrev_b32 v5, 4, v252
    ds_read_b128 v[72:75], v4 offset:20480
    ds_read_b128 v[76:79], v4 offset:21504
    ds_read_b128 v[120:123], v5 offset:17664
    ds_read_b128 v[124:127], v5 offset:17664
    ds_read_b128 v[128:131], v5 offset:17664
    ds_read_b128 v[132:135], v5 offset:17664
    ds_read_b128 v[184:187], v5 offset:17792
    ds_read_b128 v[188:191], v5 offset:17824
    ds_read_b128 v[192:195], v5 offset:17856
    ds_read_b128 v[196:199], v5 offset:17888
    ds_read_b128 v[136:139], v5 offset:17696
    ds_read_b128 v[152:155], v5 offset:17728
    ds_read_b128 v[168:171], v5 offset:17760
    s_waitcnt vmcnt(4) lgkmcnt(7)
    v_mfma_f32_32x32x16_bf16 v[200:215], v[72:75], v[8:11], v[120:135]
    ds_read_b128 v[80:83], v4 offset:22528
    ds_read_b128 v[84:87], v4 offset:23552
    ds_read_b128 v[140:143], v5 offset:17696
    ds_read_b128 v[144:147], v5 offset:17696
    ds_read_b128 v[148:151], v5 offset:17696
    v_mfma_f32_32x32x16_bf16 v[200:215], v[76:79], v[12:15], v[200:215]
    s_waitcnt lgkmcnt(5)
    ds_read_b128 v[88:91], v4 offset:24576
    ds_read_b128 v[92:95], v4 offset:25600
    ds_read_b128 v[156:159], v5 offset:17728
    ds_read_b128 v[160:163], v5 offset:17728
    ds_read_b128 v[164:167], v5 offset:17728
    v_mul_f32 v248, v184, |v120|
    v_fma_f32 v248, v185, |v121|, v248
    v_fma_f32 v248, v186, |v122|, v248
    v_fma_f32 v248, v187, |v123|, v248
    v_fma_f32 v248, v188, |v136|, v248
    v_fma_f32 v248, v189, |v137|, v248
    v_fma_f32 v248, v190, |v138|, v248
    v_fma_f32 v248, v191, |v139|, v248
    v_fma_f32 v248, v192, |v152|, v248
    v_fma_f32 v248, v193, |v153|, v248
    v_fma_f32 v248, v194, |v154|, v248
    v_fma_f32 v248, v195, |v155|, v248
    v_fma_f32 v248, v196, |v168|, v248
    v_fma_f32 v248, v197, |v169|, v248
    v_fma_f32 v248, v198, |v170|, v248
    v_fma_f32 v248, v199, |v171|, v248
    buffer_load_dwordx4 v[40:43], v250, s[8:11], s33 offen offset:0
    buffer_load_dwordx4 v[44:47], v250, s[8:11], s33 offen offset:16
    v_mfma_f32_32x32x16_bf16 v[216:231], v[72:75], v[16:19], v[120:135]
    v_fma_f32 v232, v184, |v200|, -v248
    v_fma_f32 v233, v184, |v204|, -v248
    v_fma_f32 v234, v184, |v208|, -v248
    v_fma_f32 v235, v184, |v212|, -v248
    v_fma_f32 v232, v185, |v201|, v232
    v_mfma_f32_32x32x16_bf16 v[216:231], v[76:79], v[20:23], v[216:231]
    v_fma_f32 v233, v185, |v205|, v233
    v_fma_f32 v234, v185, |v209|, v234
    v_fma_f32 v235, v185, |v213|, v235
    v_fma_f32 v232, v186, |v202|, v232
    v_fma_f32 v233, v186, |v206|, v233
    v_fma_f32 v234, v186, |v210|, v234
    v_fma_f32 v235, v186, |v214|, v235
    v_fma_f32 v232, v187, |v203|, v232
    v_fma_f32 v233, v187, |v207|, v233
    v_fma_f32 v234, v187, |v211|, v234
    v_fma_f32 v235, v187, |v215|, v235
    s_waitcnt lgkmcnt(5)
    ds_read_b128 v[96:99], v4 offset:26624
    ds_read_b128 v[100:103], v4 offset:27648
    ds_read_b128 v[172:175], v5 offset:17760
    ds_read_b128 v[176:179], v5 offset:17760
    ds_read_b128 v[180:183], v5 offset:17760
    buffer_load_dwordx4 v[48:51], v250, s[8:11], s33 offen offset:2048
    buffer_load_dwordx4 v[52:55], v250, s[8:11], s33 offen offset:2064
    v_mfma_f32_32x32x16_bf16 v[200:215], v[80:83], v[8:11], v[136:151]
    v_fma_f32 v236, v184, |v216|, -v248
    v_fma_f32 v237, v184, |v220|, -v248
    v_fma_f32 v238, v184, |v224|, -v248
    v_fma_f32 v239, v184, |v228|, -v248
    v_fma_f32 v236, v185, |v217|, v236
    v_mfma_f32_32x32x16_bf16 v[200:215], v[84:87], v[12:15], v[200:215]
    v_fma_f32 v237, v185, |v221|, v237
    v_fma_f32 v238, v185, |v225|, v238
    v_fma_f32 v239, v185, |v229|, v239
    v_fma_f32 v236, v186, |v218|, v236
    v_fma_f32 v237, v186, |v222|, v237
    v_fma_f32 v238, v186, |v226|, v238
    v_fma_f32 v239, v186, |v230|, v239
    v_fma_f32 v236, v187, |v219|, v236
    v_fma_f32 v237, v187, |v223|, v237
    v_fma_f32 v238, v187, |v227|, v238
    v_fma_f32 v239, v187, |v231|, v239
    buffer_load_dwordx4 v[56:59], v251, s[8:11], s33 offen offset:0
    buffer_load_dwordx4 v[60:63], v251, s[8:11], s33 offen offset:16
    v_mfma_f32_32x32x16_bf16 v[216:231], v[80:83], v[16:19], v[136:151]
    v_fma_f32 v232, v188, |v200|, v232
    v_fma_f32 v233, v188, |v204|, v233
    v_fma_f32 v234, v188, |v208|, v234
    v_fma_f32 v235, v188, |v212|, v235
    v_fma_f32 v232, v189, |v201|, v232
    v_mfma_f32_32x32x16_bf16 v[216:231], v[84:87], v[20:23], v[216:231]
    v_fma_f32 v233, v189, |v205|, v233
    v_fma_f32 v234, v189, |v209|, v234
    v_fma_f32 v235, v189, |v213|, v235
    v_fma_f32 v232, v190, |v202|, v232
    v_fma_f32 v233, v190, |v206|, v233
    v_fma_f32 v234, v190, |v210|, v234
    v_fma_f32 v235, v190, |v214|, v235
    v_fma_f32 v232, v191, |v203|, v232
    v_fma_f32 v233, v191, |v207|, v233
    v_fma_f32 v234, v191, |v211|, v234
    v_fma_f32 v235, v191, |v215|, v235
    s_waitcnt lgkmcnt(5)
    buffer_load_dwordx4 v[64:67], v251, s[8:11], s33 offen offset:2048
    buffer_load_dwordx4 v[68:71], v251, s[8:11], s33 offen offset:2064
    v_mfma_f32_32x32x16_bf16 v[200:215], v[88:91], v[8:11], v[152:167]
    v_fma_f32 v236, v188, |v216|, v236
    v_fma_f32 v237, v188, |v220|, v237
    v_fma_f32 v238, v188, |v224|, v238
    v_fma_f32 v239, v188, |v228|, v239
    v_fma_f32 v236, v189, |v217|, v236
    v_mfma_f32_32x32x16_bf16 v[200:215], v[92:95], v[12:15], v[200:215]
    v_fma_f32 v237, v189, |v221|, v237
    v_fma_f32 v238, v189, |v225|, v238
    v_fma_f32 v239, v189, |v229|, v239
    v_fma_f32 v236, v190, |v218|, v236
    v_fma_f32 v237, v190, |v222|, v237
    v_fma_f32 v238, v190, |v226|, v238
    v_fma_f32 v239, v190, |v230|, v239
    v_fma_f32 v236, v191, |v219|, v236
    v_fma_f32 v237, v191, |v223|, v237
    v_fma_f32 v238, v191, |v227|, v238
    v_fma_f32 v239, v191, |v231|, v239
    v_mfma_f32_32x32x16_bf16 v[216:231], v[88:91], v[16:19], v[152:167]
    v_fma_f32 v232, v192, |v200|, v232
    v_fma_f32 v233, v192, |v204|, v233
    v_fma_f32 v234, v192, |v208|, v234
    v_fma_f32 v235, v192, |v212|, v235
    v_fma_f32 v232, v193, |v201|, v232
    v_mfma_f32_32x32x16_bf16 v[216:231], v[92:95], v[20:23], v[216:231]
    v_fma_f32 v233, v193, |v205|, v233
    v_fma_f32 v234, v193, |v209|, v234
    v_fma_f32 v235, v193, |v213|, v235
    v_fma_f32 v232, v194, |v202|, v232
    v_fma_f32 v233, v194, |v206|, v233
    v_fma_f32 v234, v194, |v210|, v234
    v_fma_f32 v235, v194, |v214|, v235
    v_fma_f32 v232, v195, |v203|, v232
    v_fma_f32 v233, v195, |v207|, v233
    v_fma_f32 v234, v195, |v211|, v234
    v_fma_f32 v235, v195, |v215|, v235
    v_mov_b32 v5, 17648
L_sync_a5:
    ds_read_b32 v6, v5
    s_waitcnt lgkmcnt(0)
    v_cmp_gt_u32 vcc, 2, v6
    s_cbranch_vccnz L_sync_a5
    ds_read_b128 v[104:107], v4 offset:28672
    ds_read_b128 v[108:111], v4 offset:29696
    ds_read_b128 v[112:115], v4 offset:30720
    ds_read_b128 v[116:119], v4 offset:31744
    v_mfma_f32_32x32x16_bf16 v[200:215], v[96:99], v[8:11], v[168:183]
    v_fma_f32 v236, v192, |v216|, v236
    v_fma_f32 v237, v192, |v220|, v237
    v_fma_f32 v238, v192, |v224|, v238
    v_fma_f32 v239, v192, |v228|, v239
    v_fma_f32 v236, v193, |v217|, v236
    v_mfma_f32_32x32x16_bf16 v[200:215], v[100:103], v[12:15], v[200:215]
    v_fma_f32 v237, v193, |v221|, v237
    v_fma_f32 v238, v193, |v225|, v238
    v_fma_f32 v239, v193, |v229|, v239
    v_fma_f32 v236, v194, |v218|, v236
    v_fma_f32 v237, v194, |v222|, v237
    v_fma_f32 v238, v194, |v226|, v238
    v_fma_f32 v239, v194, |v230|, v239
    v_fma_f32 v236, v195, |v219|, v236
    v_fma_f32 v237, v195, |v223|, v237
    v_fma_f32 v238, v195, |v227|, v238
    v_fma_f32 v239, v195, |v231|, v239
    v_mfma_f32_32x32x16_bf16 v[216:231], v[96:99], v[16:19], v[168:183]
    v_fma_f32 v232, v196, |v200|, v232
    v_fma_f32 v233, v196, |v204|, v233
    v_fma_f32 v234, v196, |v208|, v234
    v_fma_f32 v235, v196, |v212|, v235
    v_fma_f32 v232, v197, |v201|, v232
    v_mfma_f32_32x32x16_bf16 v[216:231], v[100:103], v[20:23], v[216:231]
    v_fma_f32 v233, v197, |v205|, v233
    v_fma_f32 v234, v197, |v209|, v234
    v_fma_f32 v235, v197, |v213|, v235
    v_fma_f32 v232, v198, |v202|, v232
    v_fma_f32 v233, v198, |v206|, v233
    v_fma_f32 v234, v198, |v210|, v234
    v_fma_f32 v235, v198, |v214|, v235
    v_fma_f32 v232, v199, |v203|, v232
    v_fma_f32 v233, v199, |v207|, v233
    v_fma_f32 v234, v199, |v211|, v234
    v_fma_f32 v235, v199, |v215|, v235
    s_waitcnt lgkmcnt(0)
    v_mfma_f32_32x32x16_bf16 v[200:215], v[104:107], v[8:11], 0
    v_fma_f32 v236, v196, |v216|, v236
    v_fma_f32 v237, v196, |v220|, v237
    v_fma_f32 v238, v196, |v224|, v238
    v_fma_f32 v239, v196, |v228|, v239
    v_mfma_f32_32x32x16_bf16 v[200:215], v[108:111], v[12:15], v[200:215]
    v_fma_f32 v236, v197, |v217|, v236
    v_fma_f32 v237, v197, |v221|, v237
    v_fma_f32 v238, v197, |v225|, v238
    v_fma_f32 v239, v197, |v229|, v239
    v_mfma_f32_32x32x16_bf16 v[200:215], v[112:115], v[16:19], v[200:215]
    v_fma_f32 v236, v198, |v218|, v236
    v_fma_f32 v237, v198, |v222|, v237
    v_fma_f32 v238, v198, |v226|, v238
    v_fma_f32 v239, v198, |v230|, v239
    v_mfma_f32_32x32x16_bf16 v[200:215], v[116:119], v[20:23], v[200:215]
    v_fma_f32 v236, v199, |v219|, v236
    v_fma_f32 v237, v199, |v223|, v237
    v_fma_f32 v238, v199, |v227|, v238
    v_fma_f32 v239, v199, |v231|, v239
    s_waitcnt vmcnt(8)
    v_mfma_f32_32x32x16_bf16 v[216:231], v[72:75], v[24:27], v[120:135]
    v_permlane32_swap_b32 v232, v236
    v_permlane32_swap_b32 v233, v237
    v_permlane32_swap_b32 v234, v238
    v_permlane32_swap_b32 v235, v239
    v_add_f32 v232, v232, v236
    v_add_f32 v233, v233, v237
    v_mfma_f32_32x32x16_bf16 v[216:231], v[76:79], v[28:31], v[216:231]
    v_add_f32 v234, v234, v238
    v_add_f32 v235, v235, v239
    v_add_f32 v232, v232, v200
    v_add_f32 v233, v233, v204
    v_add_f32 v234, v234, v208
    v_add_f32 v235, v235, v212
    v_exp_f32 v232, v232
    v_exp_f32 v233, v233
    v_exp_f32 v234, v234
    v_exp_f32 v235, v235
    v_mul_f32 v236, v232, v201
    v_mul_f32 v237, v233, v205
    v_mul_f32 v238, v234, v209
    v_mul_f32 v239, v235, v213
    v_cvt_pk_bf16_f32 v232, v236, v232
    v_cvt_pk_bf16_f32 v233, v237, v233
    v_cvt_pk_bf16_f32 v234, v238, v234
    v_cvt_pk_bf16_f32 v235, v239, v235
    ds_write_b128 v249, v[232:235] offset:16
    v_mfma_f32_32x32x16_bf16 v[200:215], v[72:75], v[32:35], v[120:135]
    v_fma_f32 v240, v184, |v216|, -v248
    v_fma_f32 v241, v184, |v220|, -v248
    v_fma_f32 v242, v184, |v224|, -v248
    v_fma_f32 v243, v184, |v228|, -v248
    v_fma_f32 v240, v185, |v217|, v240
    v_mfma_f32_32x32x16_bf16 v[200:215], v[76:79], v[36:39], v[200:215]
    v_fma_f32 v241, v185, |v221|, v241
    v_fma_f32 v242, v185, |v225|, v242
    v_fma_f32 v243, v185, |v229|, v243
    v_fma_f32 v240, v186, |v218|, v240
    v_fma_f32 v241, v186, |v222|, v241
    v_fma_f32 v242, v186, |v226|, v242
    v_fma_f32 v243, v186, |v230|, v243
    v_fma_f32 v240, v187, |v219|, v240
    v_fma_f32 v241, v187, |v223|, v241
    v_fma_f32 v242, v187, |v227|, v242
    v_fma_f32 v243, v187, |v231|, v243
    v_mfma_f32_32x32x16_bf16 v[216:231], v[80:83], v[24:27], v[136:151]
    v_fma_f32 v244, v184, |v200|, -v248
    v_fma_f32 v245, v184, |v204|, -v248
    v_fma_f32 v246, v184, |v208|, -v248
    v_fma_f32 v247, v184, |v212|, -v248
    v_fma_f32 v244, v185, |v201|, v244
    v_mfma_f32_32x32x16_bf16 v[216:231], v[84:87], v[28:31], v[216:231]
    v_fma_f32 v245, v185, |v205|, v245
    v_fma_f32 v246, v185, |v209|, v246
    v_fma_f32 v247, v185, |v213|, v247
    v_fma_f32 v244, v186, |v202|, v244
    v_fma_f32 v245, v186, |v206|, v245
    v_fma_f32 v246, v186, |v210|, v246
    v_fma_f32 v247, v186, |v214|, v247
    v_fma_f32 v244, v187, |v203|, v244
    v_fma_f32 v245, v187, |v207|, v245
    v_fma_f32 v246, v187, |v211|, v246
    v_fma_f32 v247, v187, |v215|, v247
    v_mfma_f32_32x32x16_bf16 v[200:215], v[80:83], v[32:35], v[136:151]
    v_fma_f32 v240, v188, |v216|, v240
    v_fma_f32 v241, v188, |v220|, v241
    v_fma_f32 v242, v188, |v224|, v242
    v_fma_f32 v243, v188, |v228|, v243
    v_fma_f32 v240, v189, |v217|, v240
    v_mfma_f32_32x32x16_bf16 v[200:215], v[84:87], v[36:39], v[200:215]
    v_fma_f32 v241, v189, |v221|, v241
    v_fma_f32 v242, v189, |v225|, v242
    v_fma_f32 v243, v189, |v229|, v243
    v_fma_f32 v240, v190, |v218|, v240
    v_fma_f32 v241, v190, |v222|, v241
    v_fma_f32 v242, v190, |v226|, v242
    v_fma_f32 v243, v190, |v230|, v243
    v_fma_f32 v240, v191, |v219|, v240
    v_fma_f32 v241, v191, |v223|, v241
    v_fma_f32 v242, v191, |v227|, v242
    v_fma_f32 v243, v191, |v231|, v243
    v_mfma_f32_32x32x16_bf16 v[216:231], v[88:91], v[24:27], v[152:167]
    v_fma_f32 v244, v188, |v200|, v244
    v_fma_f32 v245, v188, |v204|, v245
    v_fma_f32 v246, v188, |v208|, v246
    v_fma_f32 v247, v188, |v212|, v247
    v_fma_f32 v244, v189, |v201|, v244
    v_mfma_f32_32x32x16_bf16 v[216:231], v[92:95], v[28:31], v[216:231]
    v_fma_f32 v245, v189, |v205|, v245
    v_fma_f32 v246, v189, |v209|, v246
    v_fma_f32 v247, v189, |v213|, v247
    v_fma_f32 v244, v190, |v202|, v244
    v_fma_f32 v245, v190, |v206|, v245
    v_fma_f32 v246, v190, |v210|, v246
    v_fma_f32 v247, v190, |v214|, v247
    v_fma_f32 v244, v191, |v203|, v244
    v_fma_f32 v245, v191, |v207|, v245
    v_fma_f32 v246, v191, |v211|, v246
    v_fma_f32 v247, v191, |v215|, v247
    v_mfma_f32_32x32x16_bf16 v[200:215], v[88:91], v[32:35], v[152:167]
    v_fma_f32 v240, v192, |v216|, v240
    v_fma_f32 v241, v192, |v220|, v241
    v_fma_f32 v242, v192, |v224|, v242
    v_fma_f32 v243, v192, |v228|, v243
    v_fma_f32 v240, v193, |v217|, v240
    v_mfma_f32_32x32x16_bf16 v[200:215], v[92:95], v[36:39], v[200:215]
    v_fma_f32 v241, v193, |v221|, v241
    v_fma_f32 v242, v193, |v225|, v242
    v_fma_f32 v243, v193, |v229|, v243
    v_fma_f32 v240, v194, |v218|, v240
    v_fma_f32 v241, v194, |v222|, v241
    v_fma_f32 v242, v194, |v226|, v242
    v_fma_f32 v243, v194, |v230|, v243
    v_fma_f32 v240, v195, |v219|, v240
    v_fma_f32 v241, v195, |v223|, v241
    v_fma_f32 v242, v195, |v227|, v242
    v_fma_f32 v243, v195, |v231|, v243
    v_mfma_f32_32x32x16_bf16 v[216:231], v[96:99], v[24:27], v[168:183]
    v_fma_f32 v244, v192, |v200|, v244
    v_fma_f32 v245, v192, |v204|, v245
    v_fma_f32 v246, v192, |v208|, v246
    v_fma_f32 v247, v192, |v212|, v247
    v_fma_f32 v244, v193, |v201|, v244
    v_mfma_f32_32x32x16_bf16 v[216:231], v[100:103], v[28:31], v[216:231]
    v_fma_f32 v245, v193, |v205|, v245
    v_fma_f32 v246, v193, |v209|, v246
    v_fma_f32 v247, v193, |v213|, v247
    v_fma_f32 v244, v194, |v202|, v244
    v_fma_f32 v245, v194, |v206|, v245
    v_fma_f32 v246, v194, |v210|, v246
    v_fma_f32 v247, v194, |v214|, v247
    v_fma_f32 v244, v195, |v203|, v244
    v_fma_f32 v245, v195, |v207|, v245
    v_fma_f32 v246, v195, |v211|, v246
    v_fma_f32 v247, v195, |v215|, v247
    v_mfma_f32_32x32x16_bf16 v[200:215], v[96:99], v[32:35], v[168:183]
    v_fma_f32 v240, v196, |v216|, v240
    v_fma_f32 v241, v196, |v220|, v241
    v_fma_f32 v242, v196, |v224|, v242
    v_fma_f32 v243, v196, |v228|, v243
    v_fma_f32 v240, v197, |v217|, v240
    v_mfma_f32_32x32x16_bf16 v[200:215], v[100:103], v[36:39], v[200:215]
    v_fma_f32 v241, v197, |v221|, v241
    v_fma_f32 v242, v197, |v225|, v242
    v_fma_f32 v243, v197, |v229|, v243
    v_fma_f32 v240, v198, |v218|, v240
    v_fma_f32 v241, v198, |v222|, v241
    v_fma_f32 v242, v198, |v226|, v242
    v_fma_f32 v243, v198, |v230|, v243
    v_fma_f32 v240, v199, |v219|, v240
    v_fma_f32 v241, v199, |v223|, v241
    v_fma_f32 v242, v199, |v227|, v242
    v_fma_f32 v243, v199, |v231|, v243
    v_mfma_f32_32x32x16_bf16 v[216:231], v[104:107], v[24:27], 0
    v_fma_f32 v244, v196, |v200|, v244
    v_fma_f32 v245, v196, |v204|, v245
    v_fma_f32 v246, v196, |v208|, v246
    v_fma_f32 v247, v196, |v212|, v247
    v_mfma_f32_32x32x16_bf16 v[216:231], v[108:111], v[28:31], v[216:231]
    v_fma_f32 v244, v197, |v201|, v244
    v_fma_f32 v245, v197, |v205|, v245
    v_fma_f32 v246, v197, |v209|, v246
    v_fma_f32 v247, v197, |v213|, v247
    v_mfma_f32_32x32x16_bf16 v[216:231], v[112:115], v[32:35], v[216:231]
    v_fma_f32 v244, v198, |v202|, v244
    v_fma_f32 v245, v198, |v206|, v245
    v_fma_f32 v246, v198, |v210|, v246
    v_fma_f32 v247, v198, |v214|, v247
    v_mfma_f32_32x32x16_bf16 v[216:231], v[116:119], v[36:39], v[216:231]
    v_fma_f32 v244, v199, |v203|, v244
    v_fma_f32 v245, v199, |v207|, v245
    v_fma_f32 v246, v199, |v211|, v246
    v_fma_f32 v247, v199, |v215|, v247
    s_waitcnt vmcnt(4)
    v_mfma_f32_32x32x16_bf16 v[200:215], v[72:75], v[40:43], v[120:135]
    v_permlane32_swap_b32 v240, v244
    v_permlane32_swap_b32 v241, v245
    v_permlane32_swap_b32 v242, v246
    v_permlane32_swap_b32 v243, v247
    v_add_f32 v240, v240, v244
    v_add_f32 v241, v241, v245
    v_mfma_f32_32x32x16_bf16 v[200:215], v[76:79], v[44:47], v[200:215]
    v_add_f32 v242, v242, v246
    v_add_f32 v243, v243, v247
    v_add_f32 v240, v240, v216
    v_add_f32 v241, v241, v220
    v_add_f32 v242, v242, v224
    v_add_f32 v243, v243, v228
    v_exp_f32 v240, v240
    v_exp_f32 v241, v241
    v_exp_f32 v242, v242
    v_exp_f32 v243, v243
    v_mul_f32 v244, v240, v217
    v_mul_f32 v245, v241, v221
    v_mul_f32 v246, v242, v225
    v_mul_f32 v247, v243, v229
    v_cvt_pk_bf16_f32 v240, v244, v240
    v_cvt_pk_bf16_f32 v241, v245, v241
    v_cvt_pk_bf16_f32 v242, v246, v242
    v_cvt_pk_bf16_f32 v243, v247, v243
    ds_write_b128 v249, v[240:243] offset:1040
    v_mfma_f32_32x32x16_bf16 v[216:231], v[72:75], v[48:51], v[120:135]
    v_fma_f32 v232, v184, |v200|, -v248
    v_fma_f32 v233, v184, |v204|, -v248
    v_fma_f32 v234, v184, |v208|, -v248
    v_fma_f32 v235, v184, |v212|, -v248
    v_fma_f32 v232, v185, |v201|, v232
    v_mfma_f32_32x32x16_bf16 v[216:231], v[76:79], v[52:55], v[216:231]
    v_fma_f32 v233, v185, |v205|, v233
    v_fma_f32 v234, v185, |v209|, v234
    v_fma_f32 v235, v185, |v213|, v235
    v_fma_f32 v232, v186, |v202|, v232
    v_fma_f32 v233, v186, |v206|, v233
    v_fma_f32 v234, v186, |v210|, v234
    v_fma_f32 v235, v186, |v214|, v235
    v_fma_f32 v232, v187, |v203|, v232
    v_fma_f32 v233, v187, |v207|, v233
    v_fma_f32 v234, v187, |v211|, v234
    v_fma_f32 v235, v187, |v215|, v235
    v_mfma_f32_32x32x16_bf16 v[200:215], v[80:83], v[40:43], v[136:151]
    v_fma_f32 v236, v184, |v216|, -v248
    v_fma_f32 v237, v184, |v220|, -v248
    v_fma_f32 v238, v184, |v224|, -v248
    v_fma_f32 v239, v184, |v228|, -v248
    v_fma_f32 v236, v185, |v217|, v236
    v_mfma_f32_32x32x16_bf16 v[200:215], v[84:87], v[44:47], v[200:215]
    v_fma_f32 v237, v185, |v221|, v237
    v_fma_f32 v238, v185, |v225|, v238
    v_fma_f32 v239, v185, |v229|, v239
    v_fma_f32 v236, v186, |v218|, v236
    v_fma_f32 v237, v186, |v222|, v237
    v_fma_f32 v238, v186, |v226|, v238
    v_fma_f32 v239, v186, |v230|, v239
    v_fma_f32 v236, v187, |v219|, v236
    v_fma_f32 v237, v187, |v223|, v237
    v_fma_f32 v238, v187, |v227|, v238
    v_fma_f32 v239, v187, |v231|, v239
    v_mfma_f32_32x32x16_bf16 v[216:231], v[80:83], v[48:51], v[136:151]
    v_fma_f32 v232, v188, |v200|, v232
    v_fma_f32 v233, v188, |v204|, v233
    v_fma_f32 v234, v188, |v208|, v234
    v_fma_f32 v235, v188, |v212|, v235
    v_fma_f32 v232, v189, |v201|, v232
    v_mfma_f32_32x32x16_bf16 v[216:231], v[84:87], v[52:55], v[216:231]
    v_fma_f32 v233, v189, |v205|, v233
    v_fma_f32 v234, v189, |v209|, v234
    v_fma_f32 v235, v189, |v213|, v235
    v_fma_f32 v232, v190, |v202|, v232
    v_fma_f32 v233, v190, |v206|, v233
    v_fma_f32 v234, v190, |v210|, v234
    v_fma_f32 v235, v190, |v214|, v235
    v_fma_f32 v232, v191, |v203|, v232
    v_fma_f32 v233, v191, |v207|, v233
    v_fma_f32 v234, v191, |v211|, v234
    v_fma_f32 v235, v191, |v215|, v235
    v_mfma_f32_32x32x16_bf16 v[200:215], v[88:91], v[40:43], v[152:167]
    v_fma_f32 v236, v188, |v216|, v236
    v_fma_f32 v237, v188, |v220|, v237
    v_fma_f32 v238, v188, |v224|, v238
    v_fma_f32 v239, v188, |v228|, v239
    v_fma_f32 v236, v189, |v217|, v236
    v_mfma_f32_32x32x16_bf16 v[200:215], v[92:95], v[44:47], v[200:215]
    v_fma_f32 v237, v189, |v221|, v237
    v_fma_f32 v238, v189, |v225|, v238
    v_fma_f32 v239, v189, |v229|, v239
    v_fma_f32 v236, v190, |v218|, v236
    v_fma_f32 v237, v190, |v222|, v237
    v_fma_f32 v238, v190, |v226|, v238
    v_fma_f32 v239, v190, |v230|, v239
    v_fma_f32 v236, v191, |v219|, v236
    v_fma_f32 v237, v191, |v223|, v237
    v_fma_f32 v238, v191, |v227|, v238
    v_fma_f32 v239, v191, |v231|, v239
    v_mfma_f32_32x32x16_bf16 v[216:231], v[88:91], v[48:51], v[152:167]
    v_fma_f32 v232, v192, |v200|, v232
    v_fma_f32 v233, v192, |v204|, v233
    v_fma_f32 v234, v192, |v208|, v234
    v_fma_f32 v235, v192, |v212|, v235
    v_fma_f32 v232, v193, |v201|, v232
    v_mfma_f32_32x32x16_bf16 v[216:231], v[92:95], v[52:55], v[216:231]
    v_fma_f32 v233, v193, |v205|, v233
    v_fma_f32 v234, v193, |v209|, v234
    v_fma_f32 v235, v193, |v213|, v235
    v_fma_f32 v232, v194, |v202|, v232
    v_fma_f32 v233, v194, |v206|, v233
    v_fma_f32 v234, v194, |v210|, v234
    v_fma_f32 v235, v194, |v214|, v235
    v_fma_f32 v232, v195, |v203|, v232
    v_fma_f32 v233, v195, |v207|, v233
    v_fma_f32 v234, v195, |v211|, v234
    v_fma_f32 v235, v195, |v215|, v235
    v_mfma_f32_32x32x16_bf16 v[200:215], v[96:99], v[40:43], v[168:183]
    v_fma_f32 v236, v192, |v216|, v236
    v_fma_f32 v237, v192, |v220|, v237
    v_fma_f32 v238, v192, |v224|, v238
    v_fma_f32 v239, v192, |v228|, v239
    v_fma_f32 v236, v193, |v217|, v236
    v_mfma_f32_32x32x16_bf16 v[200:215], v[100:103], v[44:47], v[200:215]
    v_fma_f32 v237, v193, |v221|, v237
    v_fma_f32 v238, v193, |v225|, v238
    v_fma_f32 v239, v193, |v229|, v239
    v_fma_f32 v236, v194, |v218|, v236
    v_fma_f32 v237, v194, |v222|, v237
    v_fma_f32 v238, v194, |v226|, v238
    v_fma_f32 v239, v194, |v230|, v239
    v_fma_f32 v236, v195, |v219|, v236
    v_fma_f32 v237, v195, |v223|, v237
    v_fma_f32 v238, v195, |v227|, v238
    v_fma_f32 v239, v195, |v231|, v239
    v_mfma_f32_32x32x16_bf16 v[216:231], v[96:99], v[48:51], v[168:183]
    v_fma_f32 v232, v196, |v200|, v232
    v_fma_f32 v233, v196, |v204|, v233
    v_fma_f32 v234, v196, |v208|, v234
    v_fma_f32 v235, v196, |v212|, v235
    v_fma_f32 v232, v197, |v201|, v232
    v_mfma_f32_32x32x16_bf16 v[216:231], v[100:103], v[52:55], v[216:231]
    v_fma_f32 v233, v197, |v205|, v233
    v_fma_f32 v234, v197, |v209|, v234
    v_fma_f32 v235, v197, |v213|, v235
    v_fma_f32 v232, v198, |v202|, v232
    v_fma_f32 v233, v198, |v206|, v233
    v_fma_f32 v234, v198, |v210|, v234
    v_fma_f32 v235, v198, |v214|, v235
    v_fma_f32 v232, v199, |v203|, v232
    v_fma_f32 v233, v199, |v207|, v233
    v_fma_f32 v234, v199, |v211|, v234
    v_fma_f32 v235, v199, |v215|, v235
    v_mfma_f32_32x32x16_bf16 v[200:215], v[104:107], v[40:43], 0
    v_fma_f32 v236, v196, |v216|, v236
    v_fma_f32 v237, v196, |v220|, v237
    v_fma_f32 v238, v196, |v224|, v238
    v_fma_f32 v239, v196, |v228|, v239
    v_mfma_f32_32x32x16_bf16 v[200:215], v[108:111], v[44:47], v[200:215]
    v_fma_f32 v236, v197, |v217|, v236
    v_fma_f32 v237, v197, |v221|, v237
    v_fma_f32 v238, v197, |v225|, v238
    v_fma_f32 v239, v197, |v229|, v239
    v_mfma_f32_32x32x16_bf16 v[200:215], v[112:115], v[48:51], v[200:215]
    v_fma_f32 v236, v198, |v218|, v236
    v_fma_f32 v237, v198, |v222|, v237
    v_fma_f32 v238, v198, |v226|, v238
    v_fma_f32 v239, v198, |v230|, v239
    v_mfma_f32_32x32x16_bf16 v[200:215], v[116:119], v[52:55], v[200:215]
    v_fma_f32 v236, v199, |v219|, v236
    v_fma_f32 v237, v199, |v223|, v237
    v_fma_f32 v238, v199, |v227|, v238
    v_fma_f32 v239, v199, |v231|, v239
    s_waitcnt vmcnt(0)
    v_mfma_f32_32x32x16_bf16 v[216:231], v[72:75], v[56:59], v[120:135]
    v_permlane32_swap_b32 v232, v236
    v_permlane32_swap_b32 v233, v237
    v_permlane32_swap_b32 v234, v238
    v_permlane32_swap_b32 v235, v239
    v_add_f32 v232, v232, v236
    v_add_f32 v233, v233, v237
    v_mfma_f32_32x32x16_bf16 v[216:231], v[76:79], v[60:63], v[216:231]
    v_add_f32 v234, v234, v238
    v_add_f32 v235, v235, v239
    v_add_f32 v232, v232, v200
    v_add_f32 v233, v233, v204
    v_add_f32 v234, v234, v208
    v_add_f32 v235, v235, v212
    v_exp_f32 v232, v232
    v_exp_f32 v233, v233
    v_exp_f32 v234, v234
    v_exp_f32 v235, v235
    v_mul_f32 v236, v232, v201
    v_mul_f32 v237, v233, v205
    v_mul_f32 v238, v234, v209
    v_mul_f32 v239, v235, v213
    v_cvt_pk_bf16_f32 v232, v236, v232
    v_cvt_pk_bf16_f32 v233, v237, v233
    v_cvt_pk_bf16_f32 v234, v238, v234
    v_cvt_pk_bf16_f32 v235, v239, v235
    ds_write_b128 v249, v[232:235] offset:2064
    v_mfma_f32_32x32x16_bf16 v[200:215], v[72:75], v[64:67], v[120:135]
    v_fma_f32 v240, v184, |v216|, -v248
    v_fma_f32 v241, v184, |v220|, -v248
    v_fma_f32 v242, v184, |v224|, -v248
    v_fma_f32 v243, v184, |v228|, -v248
    v_fma_f32 v240, v185, |v217|, v240
    v_mfma_f32_32x32x16_bf16 v[200:215], v[76:79], v[68:71], v[200:215]
    v_fma_f32 v241, v185, |v221|, v241
    v_fma_f32 v242, v185, |v225|, v242
    v_fma_f32 v243, v185, |v229|, v243
    v_fma_f32 v240, v186, |v218|, v240
    v_fma_f32 v241, v186, |v222|, v241
    v_fma_f32 v242, v186, |v226|, v242
    v_fma_f32 v243, v186, |v230|, v243
    v_fma_f32 v240, v187, |v219|, v240
    v_fma_f32 v241, v187, |v223|, v241
    v_fma_f32 v242, v187, |v227|, v242
    v_fma_f32 v243, v187, |v231|, v243
    v_mfma_f32_32x32x16_bf16 v[216:231], v[80:83], v[56:59], v[136:151]
    v_fma_f32 v244, v184, |v200|, -v248
    v_fma_f32 v245, v184, |v204|, -v248
    v_fma_f32 v246, v184, |v208|, -v248
    v_fma_f32 v247, v184, |v212|, -v248
    v_fma_f32 v244, v185, |v201|, v244
    v_mfma_f32_32x32x16_bf16 v[216:231], v[84:87], v[60:63], v[216:231]
    v_fma_f32 v245, v185, |v205|, v245
    v_fma_f32 v246, v185, |v209|, v246
    v_fma_f32 v247, v185, |v213|, v247
    v_fma_f32 v244, v186, |v202|, v244
    v_fma_f32 v245, v186, |v206|, v245
    v_fma_f32 v246, v186, |v210|, v246
    v_fma_f32 v247, v186, |v214|, v247
    v_fma_f32 v244, v187, |v203|, v244
    v_fma_f32 v245, v187, |v207|, v245
    v_fma_f32 v246, v187, |v211|, v246
    v_fma_f32 v247, v187, |v215|, v247
    v_mfma_f32_32x32x16_bf16 v[200:215], v[80:83], v[64:67], v[136:151]
    v_fma_f32 v240, v188, |v216|, v240
    v_fma_f32 v241, v188, |v220|, v241
    v_fma_f32 v242, v188, |v224|, v242
    v_fma_f32 v243, v188, |v228|, v243
    v_fma_f32 v240, v189, |v217|, v240
    v_mfma_f32_32x32x16_bf16 v[200:215], v[84:87], v[68:71], v[200:215]
    v_fma_f32 v241, v189, |v221|, v241
    v_fma_f32 v242, v189, |v225|, v242
    v_fma_f32 v243, v189, |v229|, v243
    v_fma_f32 v240, v190, |v218|, v240
    v_fma_f32 v241, v190, |v222|, v241
    v_fma_f32 v242, v190, |v226|, v242
    v_fma_f32 v243, v190, |v230|, v243
    v_fma_f32 v240, v191, |v219|, v240
    v_fma_f32 v241, v191, |v223|, v241
    v_fma_f32 v242, v191, |v227|, v242
    v_fma_f32 v243, v191, |v231|, v243
    v_mfma_f32_32x32x16_bf16 v[216:231], v[88:91], v[56:59], v[152:167]
    v_fma_f32 v244, v188, |v200|, v244
    v_fma_f32 v245, v188, |v204|, v245
    v_fma_f32 v246, v188, |v208|, v246
    v_fma_f32 v247, v188, |v212|, v247
    v_fma_f32 v244, v189, |v201|, v244
    v_mfma_f32_32x32x16_bf16 v[216:231], v[92:95], v[60:63], v[216:231]
    v_fma_f32 v245, v189, |v205|, v245
    v_fma_f32 v246, v189, |v209|, v246
    v_fma_f32 v247, v189, |v213|, v247
    v_fma_f32 v244, v190, |v202|, v244
    v_fma_f32 v245, v190, |v206|, v245
    v_fma_f32 v246, v190, |v210|, v246
    v_fma_f32 v247, v190, |v214|, v247
    v_fma_f32 v244, v191, |v203|, v244
    v_fma_f32 v245, v191, |v207|, v245
    v_fma_f32 v246, v191, |v211|, v246
    v_fma_f32 v247, v191, |v215|, v247
    v_mfma_f32_32x32x16_bf16 v[200:215], v[88:91], v[64:67], v[152:167]
    v_fma_f32 v240, v192, |v216|, v240
    v_fma_f32 v241, v192, |v220|, v241
    v_fma_f32 v242, v192, |v224|, v242
    v_fma_f32 v243, v192, |v228|, v243
    v_fma_f32 v240, v193, |v217|, v240
    v_mfma_f32_32x32x16_bf16 v[200:215], v[92:95], v[68:71], v[200:215]
    v_fma_f32 v241, v193, |v221|, v241
    v_fma_f32 v242, v193, |v225|, v242
    v_fma_f32 v243, v193, |v229|, v243
    v_fma_f32 v240, v194, |v218|, v240
    v_fma_f32 v241, v194, |v222|, v241
    v_fma_f32 v242, v194, |v226|, v242
    v_fma_f32 v243, v194, |v230|, v243
    v_fma_f32 v240, v195, |v219|, v240
    v_fma_f32 v241, v195, |v223|, v241
    v_fma_f32 v242, v195, |v227|, v242
    v_fma_f32 v243, v195, |v231|, v243
    v_mfma_f32_32x32x16_bf16 v[216:231], v[96:99], v[56:59], v[168:183]
    v_fma_f32 v244, v192, |v200|, v244
    v_fma_f32 v245, v192, |v204|, v245
    v_fma_f32 v246, v192, |v208|, v246
    v_fma_f32 v247, v192, |v212|, v247
    v_fma_f32 v244, v193, |v201|, v244
    v_mfma_f32_32x32x16_bf16 v[216:231], v[100:103], v[60:63], v[216:231]
    v_fma_f32 v245, v193, |v205|, v245
    v_fma_f32 v246, v193, |v209|, v246
    v_fma_f32 v247, v193, |v213|, v247
    v_fma_f32 v244, v194, |v202|, v244
    v_fma_f32 v245, v194, |v206|, v245
    v_fma_f32 v246, v194, |v210|, v246
    v_fma_f32 v247, v194, |v214|, v247
    v_fma_f32 v244, v195, |v203|, v244
    v_fma_f32 v245, v195, |v207|, v245
    v_fma_f32 v246, v195, |v211|, v246
    v_fma_f32 v247, v195, |v215|, v247
    v_mfma_f32_32x32x16_bf16 v[200:215], v[96:99], v[64:67], v[168:183]
    v_fma_f32 v240, v196, |v216|, v240
    v_fma_f32 v241, v196, |v220|, v241
    v_fma_f32 v242, v196, |v224|, v242
    v_fma_f32 v243, v196, |v228|, v243
    v_fma_f32 v240, v197, |v217|, v240
    v_mfma_f32_32x32x16_bf16 v[200:215], v[100:103], v[68:71], v[200:215]
    v_fma_f32 v241, v197, |v221|, v241
    v_fma_f32 v242, v197, |v225|, v242
    v_fma_f32 v243, v197, |v229|, v243
    v_fma_f32 v240, v198, |v218|, v240
    v_fma_f32 v241, v198, |v222|, v241
    v_fma_f32 v242, v198, |v226|, v242
    v_fma_f32 v243, v198, |v230|, v243
    v_fma_f32 v240, v199, |v219|, v240
    v_fma_f32 v241, v199, |v223|, v241
    v_fma_f32 v242, v199, |v227|, v242
    v_fma_f32 v243, v199, |v231|, v243
    v_mfma_f32_32x32x16_bf16 v[216:231], v[104:107], v[56:59], 0
    v_fma_f32 v244, v196, |v200|, v244
    v_fma_f32 v245, v196, |v204|, v245
    v_fma_f32 v246, v196, |v208|, v246
    v_fma_f32 v247, v196, |v212|, v247
    v_mfma_f32_32x32x16_bf16 v[216:231], v[108:111], v[60:63], v[216:231]
    v_fma_f32 v244, v197, |v201|, v244
    v_fma_f32 v245, v197, |v205|, v245
    v_fma_f32 v246, v197, |v209|, v246
    v_fma_f32 v247, v197, |v213|, v247
    v_mfma_f32_32x32x16_bf16 v[216:231], v[112:115], v[64:67], v[216:231]
    v_fma_f32 v244, v198, |v202|, v244
    v_fma_f32 v245, v198, |v206|, v245
    v_fma_f32 v246, v198, |v210|, v246
    v_fma_f32 v247, v198, |v214|, v247
    v_mfma_f32_32x32x16_bf16 v[216:231], v[116:119], v[68:71], v[216:231]
    v_fma_f32 v244, v199, |v203|, v244
    v_fma_f32 v245, v199, |v207|, v245
    v_fma_f32 v246, v199, |v211|, v246
    v_fma_f32 v247, v199, |v215|, v247
    s_nop 1
    v_permlane32_swap_b32 v240, v244
    v_permlane32_swap_b32 v241, v245
    v_permlane32_swap_b32 v242, v246
    v_permlane32_swap_b32 v243, v247
    v_add_f32 v240, v240, v244
    v_add_f32 v241, v241, v245
    v_add_f32 v242, v242, v246
    v_add_f32 v243, v243, v247
    v_add_f32 v240, v240, v216
    v_add_f32 v241, v241, v220
    v_add_f32 v242, v242, v224
    v_add_f32 v243, v243, v228
    v_exp_f32 v240, v240
    v_exp_f32 v241, v241
    v_exp_f32 v242, v242
    v_exp_f32 v243, v243
    v_mul_f32 v244, v240, v217
    v_mul_f32 v245, v241, v221
    v_mul_f32 v246, v242, v225
    v_mul_f32 v247, v243, v229
    v_cvt_pk_bf16_f32 v240, v244, v240
    v_cvt_pk_bf16_f32 v241, v245, v241
    v_cvt_pk_bf16_f32 v242, v246, v242
    v_cvt_pk_bf16_f32 v243, v247, v243
    ds_write_b128 v249, v[240:243] offset:3088
    s_waitcnt lgkmcnt(0)
    v_mov_b32 v5, 17660
    v_mov_b32 v6, 1
    s_mov_b64 exec, 1
    ds_add_u32 v5, v6
    s_mov_b64 exec, -1
L_hi_final:
    s_and_b32 s36, s2, 6
    s_lshl_b32 s36, s36, 5
    s_lshr_b32 s56, s2, 3
    s_lshl_b32 s56, s56, 1
    s_or_b32 s36, s36, s56
    s_and_b32 s56, s2, 1
    s_or_b32 s36, s36, s56
    s_add_u32 s54, s54, 1
    s_and_b32 s56, s54, 255
    s_xor_b32 s57, s54, 1
    s_and_b32 s57, s57, 3
    s_lshl_b32 s57, s57, 8
    s_or_b32 s56, s56, s57
    s_lshr_b32 s57, s54, 8
    s_lshl_b32 s57, s57, 10
    s_or_b32 s56, s56, s57
    v_and_b32 v4, 3, v0
    v_lshlrev_b32 v4, 3, v4
    v_lshrrev_b32 v4, v4, s56
    v_bfe_u32 v5, v4, 0, 2
    v_alignbit_b32 v96, v5, v5, 1
    v_bfe_u32 v5, v4, 2, 2
    v_alignbit_b32 v97, v5, v5, 1
    v_bfe_u32 v5, v4, 4, 2
    v_alignbit_b32 v98, v5, v5, 1
    v_bfe_u32 v5, v4, 6, 2
    v_alignbit_b32 v99, v5, v5, 1
    v_and_b32 v2, 255, v0
    v_lshlrev_b32 v32, 4, v2
    v_add_u32 v33, 0x2000, v32
    s_lshl_b32 s56, s36, 14
    s_add_u32 s57, s56, 0x1000
    v_cmp_gt_u32 vcc, 232, v2
    s_mov_b64 s[62:63], vcc
    s_mov_b32 s58, 0
    v_mov_b32 v5, 17640
    s_branch L_sync_res
L_sync_res_z:
    s_sleep 2
L_sync_res:
    ds_read_b32 v6, v5
    s_waitcnt lgkmcnt(0)
    v_cmp_gt_u32 vcc, 8, v6
    s_cbranch_vccnz L_sync_res_z
    ds_read_b32 v6, v5 offset:16
    s_waitcnt lgkmcnt(0)
    v_readfirstlane_b32 s53, v6
    v_mov_b32 v84, -1
    v_mov_b32 v85, -1
    v_mov_b32 v86, -1
    v_mov_b32 v87, -1
    s_cmp_lg_u32 s53, 0
    s_cbranch_scc1 L_rare0
L_rare0_ret:
    s_sleep 20
L_poll2:
    s_cmp_lg_u32 s53, 0
    s_cbranch_scc1 L_rare1
L_rare1_ret:
    buffer_load_dwordx4 v[48:51], v32, s[24:27], s56 offen sc1
    buffer_load_dwordx4 v[52:55], v32, s[24:27], s57 offen sc1
    buffer_load_dwordx4 v[56:59], v33, s[24:27], s56 offen sc1
    buffer_load_dwordx4 v[60:63], v33, s[24:27], s57 offen sc1
    s_waitcnt vmcnt(3)
    v_xor_b32 v34, v48, v96
    v_bitop3_b32 v34, v34, v49, v97 bitop3:0xf6
    v_bitop3_b32 v34, v34, v50, v98 bitop3:0xf6
    v_bitop3_b32 v34, v34, v51, v99 bitop3:0xf6
    ds_write_b128 v32, v[48:51] offset:32768
    s_waitcnt vmcnt(2)
    v_bitop3_b32 v34, v34, v52, v96 bitop3:0xf6
    v_bitop3_b32 v34, v34, v53, v97 bitop3:0xf6
    v_bitop3_b32 v34, v34, v54, v98 bitop3:0xf6
    v_bitop3_b32 v34, v34, v55, v99 bitop3:0xf6
    ds_write_b128 v32, v[52:55] offset:36864
    s_waitcnt vmcnt(1)
    v_bitop3_b32 v34, v34, v56, v96 bitop3:0xf6
    v_bitop3_b32 v34, v34, v57, v97 bitop3:0xf6
    v_bitop3_b32 v34, v34, v58, v98 bitop3:0xf6
    v_bitop3_b32 v34, v34, v59, v99 bitop3:0xf6
    ds_write_b128 v32, v[56:59] offset:40960
    s_waitcnt vmcnt(0)
    v_xor_b32 v35, v60, v96
    v_bitop3_b32 v35, v35, v61, v97 bitop3:0xf6
    v_bitop3_b32 v35, v35, v62, v98 bitop3:0xf6
    v_bitop3_b32 v35, v35, v63, v99 bitop3:0xf6
    ds_write_b128 v32, v[60:63] offset:45056
    s_cmp_lg_u32 s53, 0
    s_cbranch_scc1 L_rare2
L_rare2_ret:
    v_and_b32 v35, 0x80000001, v35
    v_and_b32 v34, 0x80000001, v34
    v_cmp_ne_u32 vcc, 0, v35
    s_and_b64 s[60:61], vcc, s[62:63]
    v_cmp_ne_u32 vcc, 0, v34
    s_or_b64 vcc, vcc, s[60:61]
    s_cbranch_vccnz L_poll2_again
L_poll2_ok:
    s_waitcnt lgkmcnt(0)
    s_barrier
    s_endpgm
L_end:
    s_endpgm
L_mark:
    v_mov_b32 v7, 32768
    v_mov_b32 v6, 16512
    v_mov_b32 v4, -1
    ds_write_b32 v6, v4
    v_and_b32 v4, 30, v24
    v_lshlrev_b32 v5, 3, v32
    v_add_lshl_u32 v4, v4, v5, 1
    v_cmp_le_u32 vcc, 48, v24
    v_lshrrev_b32 v5, 5, v24
    v_lshlrev_b32 v5, 14, v5
    v_add3_u32 v4, v4, v5, v7
    v_cndmask_b32 v8, v4, v6, vcc
    v_and_b32 v4, 30, v25
    v_lshlrev_b32 v5, 3, v33
    v_add_lshl_u32 v4, v4, v5, 1
    v_cmp_le_u32 vcc, 48, v25
    v_lshrrev_b32 v5, 5, v25
    v_lshlrev_b32 v5, 14, v5
    v_add3_u32 v4, v4, v5, v7
    v_cndmask_b32 v9, v4, v6, vcc
    s_mov_b32 exec_lo, 0x77777777
    s_mov_b32 exec_hi, 0x77777777
    v_and_b32 v4, 30, v26
    v_lshlrev_b32 v5, 3, v34
    v_add_lshl_u32 v4, v4, v5, 1
    v_cmp_le_u32 vcc, 48, v26
    v_lshrrev_b32 v5, 5, v26
    v_lshlrev_b32 v5, 14, v5
    v_add3_u32 v4, v4, v5, v7
    v_cndmask_b32 v10, v4, v6, vcc
    v_and_b32 v4, 30, v27
    v_lshlrev_b32 v5, 3, v35
    v_add_lshl_u32 v4, v4, v5, 1
    v_cmp_le_u32 vcc, 48, v27
    v_lshrrev_b32 v5, 5, v27
    v_lshlrev_b32 v5, 14, v5
    v_add3_u32 v4, v4, v5, v7
    v_cndmask_b32 v11, v4, v6, vcc
    v_and_b32 v4, 30, v28
    v_lshlrev_b32 v5, 3, v36
    v_add_lshl_u32 v4, v4, v5, 1
    v_cmp_le_u32 vcc, 48, v28
    v_lshrrev_b32 v5, 5, v28
    v_lshlrev_b32 v5, 14, v5
    v_add3_u32 v4, v4, v5, v7
    v_cndmask_b32 v12, v4, v6, vcc
    v_and_b32 v4, 30, v29
    v_lshlrev_b32 v5, 3, v37
    v_add_lshl_u32 v4, v4, v5, 1
    v_cmp_le_u32 vcc, 48, v29
    v_lshrrev_b32 v5, 5, v29
    v_lshlrev_b32 v5, 14, v5
    v_add3_u32 v4, v4, v5, v7
    v_cndmask_b32 v13, v4, v6, vcc
    v_and_b32 v4, 30, v30
    v_lshlrev_b32 v5, 3, v38
    v_add_lshl_u32 v4, v4, v5, 1
    v_cmp_le_u32 vcc, 48, v30
    v_lshrrev_b32 v5, 5, v30
    v_lshlrev_b32 v5, 14, v5
    v_add3_u32 v4, v4, v5, v7
    v_cndmask_b32 v14, v4, v6, vcc
    v_and_b32 v4, 30, v31
    v_lshlrev_b32 v5, 3, v39
    v_add_lshl_u32 v4, v4, v5, 1
    v_cmp_le_u32 vcc, 48, v31
    v_lshrrev_b32 v5, 5, v31
    v_lshlrev_b32 v5, 14, v5
    v_add3_u32 v4, v4, v5, v7
    v_cndmask_b32 v15, v4, v6, vcc
    s_mov_b64 exec, -1
    v_mov_b32 v5, 17656
    v_mov_b32 v6, 1
    s_mov_b64 exec, 1
    ds_add_u32 v5, v6
    s_mov_b64 exec, -1
    s_branch L_mark_ret
L_nobucket0:
    s_waitcnt lgkmcnt(0)
    s_branch L_nobucket
L_poll1_again:
    s_add_u32 s58, s58, 1
    s_cmp_lt_u32 s58, 16384
    s_cbranch_scc1 L_poll1
    v_mov_b32 v16, 0
    v_mov_b32 v17, 0
    v_mov_b32 v18, 0
    v_mov_b32 v19, 0
    ds_write_b128 v7, v[16:19] offset:49152
    ds_write_b128 v7, v[16:19] offset:50176
    ds_write_b128 v7, v[16:19] offset:51200
    ds_write_b128 v7, v[16:19] offset:52224
    ds_write_b128 v140, v[16:19] offset:49152
    ds_write_b128 v140, v[16:19] offset:50176
    ds_write_b128 v140, v[16:19] offset:51200
    ds_write_b128 v140, v[16:19] offset:52224
    v_mov_b32 v5, 2
    s_waitcnt lgkmcnt(0)
    ds_write_b32 v2, v5
L_gaveup:
    v_or_b32 v252, 0x7fc00000, v252
    v_or_b32 v253, 0x7fc00000, v253
    v_or_b32 v254, 0x7fc00000, v254
    v_or_b32 v255, 0x7fc00000, v255
    s_branch L_poll1_ok
L_fl23:
    v_add_u32 v5, 0x1700000, v210
    v_or_b32_sdwa v7, v5, sext(v107) dst_sel:DWORD dst_unused:UNUSED_PAD src0_sel:DWORD src1_sel:WORD_1
    v_add_u32 v5, 0xfff00000, v5
    ds_write_b32 v3, v7 offset:596
    v_or_b32_sdwa v6, v5, sext(v107) dst_sel:DWORD dst_unused:UNUSED_PAD src0_sel:DWORD src1_sel:WORD_0
    v_add_u32 v5, 0xfff00000, v5
    ds_write_b32 v3, v6 offset:592
    v_or_b32_sdwa v7, v5, sext(v106) dst_sel:DWORD dst_unused:UNUSED_PAD src0_sel:DWORD src1_sel:WORD_1
    v_add_u32 v5, 0xfff00000, v5
    ds_write_b32 v3, v7 offset:588
    v_or_b32_sdwa v6, v5, sext(v106) dst_sel:DWORD dst_unused:UNUSED_PAD src0_sel:DWORD src1_sel:WORD_0
    v_add_u32 v5, 0xfff00000, v5
    ds_write_b32 v3, v6 offset:584
    v_or_b32_sdwa v7, v5, sext(v105) dst_sel:DWORD dst_unused:UNUSED_PAD src0_sel:DWORD src1_sel:WORD_1
    v_add_u32 v5, 0xfff00000, v5
    ds_write_b32 v3, v7 offset:580
    v_or_b32_sdwa v6, v5, sext(v105) dst_sel:DWORD dst_unused:UNUSED_PAD src0_sel:DWORD src1_sel:WORD_0
    v_add_u32 v5, 0xfff00000, v5
    ds_write_b32 v3, v6 offset:576
    v_or_b32_sdwa v7, v5, sext(v104) dst_sel:DWORD dst_unused:UNUSED_PAD src0_sel:DWORD src1_sel:WORD_1
    v_add_u32 v5, 0xfff00000, v5
    ds_write_b32 v3, v7 offset:572
    v_or_b32_sdwa v6, v5, sext(v104) dst_sel:DWORD dst_unused:UNUSED_PAD src0_sel:DWORD src1_sel:WORD_0
    v_add_u32 v5, 0xfff00000, v5
    ds_write_b32 v3, v6 offset:568
    s_waitcnt lgkmcnt(0)
    s_branch L_fl15
L_more:
    s_mov_b32 s3, 0
    s_sub_u32 s58, s58, 512
    v_add_u32 v250, 2048, v250
    v_add_u32 v199, 2048, v199
    v_add_u32 v7, 1024, v199
    v_mov_b32 v6, v199
    s_waitcnt vmcnt(0) lgkmcnt(0)
    ds_read_b32 v80, v250 offset:0
    ds_read_b32 v81, v250 offset:128
    ds_read_b32 v82, v250 offset:256
    ds_read_b32 v83, v250 offset:384
    ds_read_b32 v84, v250 offset:512
    ds_read_b32 v85, v250 offset:640
    ds_read_b32 v86, v250 offset:768
    ds_read_b32 v87, v250 offset:896
    s_waitcnt lgkmcnt(0)
    ds_read_b32 v88, v250 offset:1024
    ds_read_b32 v89, v250 offset:1152
    ds_read_b32 v90, v250 offset:1280
    ds_read_b32 v91, v250 offset:1408
    ds_read_b32 v92, v250 offset:1536
    ds_read_b32 v93, v250 offset:1664
    ds_read_b32 v94, v250 offset:1792
    ds_read_b32 v95, v250 offset:1920
    s_waitcnt lgkmcnt(0)
    v_lshrrev_b32 v112, 2, v80
    v_bfe_i32 v116, v80, v248, 1
    v_lshrrev_b32 v113, 2, v81
    v_bfe_i32 v117, v81, v248, 1
    v_lshrrev_b32 v114, 2, v82
    v_bfe_i32 v118, v82, v248, 1
    v_lshrrev_b32 v115, 2, v83
    v_bfe_i32 v119, v83, v248, 1
    v_and_b32 v112, v112, v198
    v_and_b32 v120, v116, v249
    v_and_b32 v113, v113, v198
    v_and_b32 v121, v117, v249
    v_and_b32 v114, v114, v198
    v_and_b32 v122, v118, v249
    v_and_b32 v115, v115, v198
    v_and_b32 v123, v119, v249
    v_add3_u32 v112, v112, v247, v120
    v_and_b32 v116, v116, v246
    v_add3_u32 v113, v113, v247, v121
    v_and_b32 v117, v117, v246
    v_add3_u32 v114, v114, v247, v122
    v_and_b32 v118, v118, v246
    v_add3_u32 v115, v115, v247, v123
    v_and_b32 v119, v119, v246
    buffer_load_dwordx4 v[16:19], v112, s[20:23], s32 offen sc1
    v_and_or_b32 v80, v80, 12, v116
    buffer_load_dwordx4 v[20:23], v113, s[20:23], s32 offen sc1
    v_and_or_b32 v81, v81, 12, v117
    buffer_load_dwordx4 v[24:27], v114, s[20:23], s32 offen sc1
    v_and_or_b32 v82, v82, 12, v118
    buffer_load_dwordx4 v[28:31], v115, s[20:23], s32 offen sc1
    v_and_or_b32 v83, v83, 12, v119
    s_branch L_round
L_late:
    ds_read2st64_b32 v[16:17], v200 offset0:0 offset1:1
    ds_read2st64_b32 v[18:19], v200 offset0:2 offset1:3
    ds_read2st64_b32 v[20:21], v214 offset0:0 offset1:1
    ds_read2st64_b32 v[22:23], v214 offset0:2 offset1:3
    ds_read2st64_b32 v[24:25], v215 offset0:0 offset1:1
    ds_read2st64_b32 v[26:27], v215 offset0:2 offset1:3
    s_waitcnt lgkmcnt(0)
    s_bitcmp1_b32 s61, 0
    s_cbranch_scc1 L_l0
    v_and_or_b32 v16, v16, v251, v252
    v_and_or_b32 v17, v17, v251, v253
    v_and_or_b32 v18, v18, v251, v254
    v_and_or_b32 v19, v19, v251, v255
    s_add_u32 s56, s35, 0x0
    buffer_store_dwordx4 v[16:19], v201, s[24:27], s56 offen sc1
    s_bitset1_b32 s61, 0
L_l0:
    s_bitcmp1_b32 s61, 1
    s_cbranch_scc1 L_l1
    v_and_or_b32 v20, v20, v251, v252
    v_and_or_b32 v21, v21, v251, v253
    v_and_or_b32 v22, v22, v251, v254
    v_and_or_b32 v23, v23, v251, v255
    s_add_u32 s56, s35, 0x40000
    buffer_store_dwordx4 v[20:23], v201, s[24:27], s56 offen sc1
    s_bitset1_b32 s61, 1
L_l1:
    s_bitcmp1_b32 s61, 2
    s_cbranch_scc1 L_l2
    v_and_or_b32 v24, v24, v251, v252
    v_and_or_b32 v25, v25, v251, v253
    v_and_or_b32 v26, v26, v251, v254
    v_and_or_b32 v27, v27, v251, v255
    s_add_u32 s56, s35, 0x80000
    buffer_store_dwordx4 v[24:27], v201, s[24:27], s56 offen sc1
    s_bitset1_b32 s61, 2
L_l2:
    s_branch L_late_ret
L_res2:
    s_add_u32 s56, s35, 0x400000
    v_add_u32 v2, 64, v200
    v_add_u32 v3, 128, v200
    v_add_u32 v4, 192, v200
    s_waitcnt lgkmcnt(6)
    ds_read2st64_b32 v[32:33], v200 offset0:16 offset1:17
    ds_read2st64_b32 v[34:35], v200 offset0:18 offset1:19
    ds_read2st64_b32 v[36:37], v2 offset0:16 offset1:17
    ds_read2st64_b32 v[38:39], v2 offset0:18 offset1:19
    ds_read2st64_b32 v[40:41], v3 offset0:16 offset1:17
    ds_read2st64_b32 v[42:43], v3 offset0:18 offset1:19
    ds_read2st64_b32 v[44:45], v4 offset0:16 offset1:17
    ds_read2st64_b32 v[46:47], v4 offset0:18 offset1:19
    s_waitcnt lgkmcnt(6)
    v_and_or_b32 v32, v32, v251, v252
    v_and_or_b32 v33, v33, v251, v253
    v_and_or_b32 v34, v34, v251, v254
    v_and_or_b32 v35, v35, v251, v255
    buffer_store_dwordx4 v[32:35], v201, s[24:27], s56 offen sc1
    s_add_u32 s56, s56, 0x40000
    s_waitcnt lgkmcnt(4)
    v_and_or_b32 v36, v36, v251, v252
    v_and_or_b32 v37, v37, v251, v253
    v_and_or_b32 v38, v38, v251, v254
    v_and_or_b32 v39, v39, v251, v255
    buffer_store_dwordx4 v[36:39], v201, s[24:27], s56 offen sc1
    s_add_u32 s56, s56, 0x40000
    s_waitcnt lgkmcnt(2)
    v_and_or_b32 v40, v40, v251, v252
    v_and_or_b32 v41, v41, v251, v253
    v_and_or_b32 v42, v42, v251, v254
    v_and_or_b32 v43, v43, v251, v255
    buffer_store_dwordx4 v[40:43], v201, s[24:27], s56 offen sc1
    s_add_u32 s56, s56, 0x40000
    s_waitcnt lgkmcnt(0)
    v_and_or_b32 v44, v44, v251, v252
    v_and_or_b32 v45, v45, v251, v253
    v_and_or_b32 v46, v46, v251, v254
    v_and_or_b32 v47, v47, v251, v255
    buffer_store_dwordx4 v[44:47], v201, s[24:27], s56 offen sc1
    s_branch L_res2_ret
L_epoch:
    s_mov_b64 exec, 1
    v_mov_b32 v4, 0x0
    v_mov_b32 v5, s54
    global_store_dword v4, v5, s[50:51] sc1
    s_mov_b64 exec, -1
    s_branch L_epoch_ret
L_hi_skip:
    s_add_u32 s24, s50, 0x800000
    s_addc_u32 s25, s51, 0
    s_mov_b32 s26, 0x800000
    s_mov_b32 s27, 0x00020000
    s_waitcnt lgkmcnt(0)
    s_branch L_hi_final
L_rare0:
    v_and_b32 v4, -4, v2
    s_add_u32 s59, s56, 0x400000
    v_mov_b32 v7, 0x80000000
    ds_read_b32 v80, v4 offset:16640
    ds_read_b32 v81, v4 offset:16896
    ds_read_b32 v82, v4 offset:17152
    ds_read_b32 v83, v4 offset:17408
    s_waitcnt lgkmcnt(0)
    v_add_u32 v80, -33, v80
    v_add_u32 v4, 0, v32
    v_and_or_b32 v84, v80, v7, v4
    v_ashrrev_i32 v80, 31, v80
    v_add_u32 v81, -33, v81
    v_add_u32 v4, 4096, v32
    v_and_or_b32 v85, v81, v7, v4
    v_ashrrev_i32 v81, 31, v81
    v_add_u32 v82, -33, v82
    v_add_u32 v4, 8192, v32
    v_and_or_b32 v86, v82, v7, v4
    v_ashrrev_i32 v82, 31, v82
    v_add_u32 v83, -33, v83
    v_add_u32 v4, 12288, v32
    v_and_or_b32 v87, v83, v7, v4
    v_ashrrev_i32 v83, 31, v83
    s_branch L_rare0_ret
L_rare1:
    buffer_load_dwordx4 v[64:67], v84, s[24:27], s59 offen sc1
    buffer_load_dwordx4 v[68:71], v85, s[24:27], s59 offen sc1
    buffer_load_dwordx4 v[72:75], v86, s[24:27], s59 offen sc1
    buffer_load_dwordx4 v[76:79], v87, s[24:27], s59 offen sc1
    s_branch L_rare1_ret
L_rare2:
    v_xor_b32 v4, v64, v96
    v_bitop3_b32 v4, v4, v65, v97 bitop3:0xf6
    v_bitop3_b32 v4, v4, v66, v98 bitop3:0xf6
    v_bitop3_b32 v4, v4, v67, v99 bitop3:0xf6
    v_bitop3_b32 v34, v34, v4, v80 bitop3:0xf4
    ds_write_b128 v32, v[64:67] offset:49152
    v_xor_b32 v4, v68, v96
    v_bitop3_b32 v4, v4, v69, v97 bitop3:0xf6
    v_bitop3_b32 v4, v4, v70, v98 bitop3:0xf6
    v_bitop3_b32 v4, v4, v71, v99 bitop3:0xf6
    v_bitop3_b32 v34, v34, v4, v81 bitop3:0xf4
    ds_write_b128 v32, v[68:71] offset:53248
    v_xor_b32 v4, v72, v96
    v_bitop3_b32 v4, v4, v73, v97 bitop3:0xf6
    v_bitop3_b32 v4, v4, v74, v98 bitop3:0xf6
    v_bitop3_b32 v4, v4, v75, v99 bitop3:0xf6
    v_bitop3_b32 v34, v34, v4, v82 bitop3:0xf4
    ds_write_b128 v32, v[72:75] offset:57344
    v_xor_b32 v4, v76, v96
    v_bitop3_b32 v4, v4, v77, v97 bitop3:0xf6
    v_bitop3_b32 v4, v4, v78, v98 bitop3:0xf6
    v_bitop3_b32 v4, v4, v79, v99 bitop3:0xf6
    v_bitop3_b32 v34, v34, v4, v83 bitop3:0xf4
    ds_write_b128 v32, v[76:79] offset:61440
    s_branch L_rare2_ret
L_poll2_again:
    s_waitcnt lgkmcnt(0)
    s_add_u32 s58, s58, 1
    s_cmp_lt_u32 s58, 16384
    s_cbranch_scc1 L_poll2
    v_mov_b32 v5, 17652
    v_mov_b32 v6, 1
    s_mov_b64 exec, 1
    ds_add_u32 v5, v6
    s_mov_b64 exec, -1
    s_branch L_poll2_ok
L_fallback:
    v_cmp_eq_u32 vcc, 0, v6
    s_cbranch_vccnz L_fb_go
    s_mov_b64 exec, 1
    v_mov_b32 v4, 0x0
    v_mov_b32 v5, s54
    global_atomic_umax v4, v5, s[50:51] sc1
    s_mov_b64 exec, -1
L_fb_go:
    v_and_b32 v100, 15, v1
    v_lshrrev_b32 v101, 4, v1
    v_lshlrev_b32 v106, 9, v101
    v_lshl_add_u32 v106, v100, 1, v106
    buffer_load_ushort v80, v106, s[12:15], 0 offen offset:0
    buffer_load_ushort v81, v106, s[12:15], 0 offen offset:64
    buffer_load_ushort v82, v106, s[12:15], 0 offen offset:128
    buffer_load_ushort v83, v106, s[12:15], 0 offen offset:192
    buffer_load_ushort v84, v106, s[12:15], 0 offen offset:256
    buffer_load_ushort v85, v106, s[12:15], 0 offen offset:320
    buffer_load_ushort v86, v106, s[12:15], 0 offen offset:384
    buffer_load_ushort v87, v106, s[12:15], 0 offen offset:448
    buffer_load_ushort v88, v106, s[12:15], 0 offen offset:32
    buffer_load_ushort v89, v106, s[12:15], 0 offen offset:96
    buffer_load_ushort v90, v106, s[12:15], 0 offen offset:160
    buffer_load_ushort v91, v106, s[12:15], 0 offen offset:224
    buffer_load_ushort v92, v106, s[12:15], 0 offen offset:288
    buffer_load_ushort v93, v106, s[12:15], 0 offen offset:352
    buffer_load_ushort v94, v106, s[12:15], 0 offen offset:416
    buffer_load_ushort v95, v106, s[12:15], 0 offen offset:480
    v_lshlrev_b32 v107, 3, v101
    v_lshlrev_b32 v101, 4, v101
    global_load_dwordx2 v[40:41], v107, s[42:43]
    global_load_dwordx2 v[42:43], v107, s[42:43] offset:32
    global_load_dwordx2 v[32:33], v107, s[44:45]
    global_load_dwordx2 v[34:35], v107, s[44:45] offset:32
    global_load_dwordx4 v[36:39], v101, s[46:47]
    s_lshl_b32 s60, s2, 6
    s_lshl_b32 s57, s52, 4
    s_add_u32 s60, s60, s57
    v_add_u32 v102, s60, v100
    v_mul_u32_u24 v102, 104, v102
    s_waitcnt vmcnt(0)
    v_lshl_or_b32 v16, v81, 16, v80
    v_lshl_or_b32 v17, v83, 16, v82
    v_lshl_or_b32 v18, v85, 16, v84
    v_lshl_or_b32 v19, v87, 16, v86
    v_lshl_or_b32 v20, v89, 16, v88
    v_lshl_or_b32 v21, v91, 16, v90
    v_lshl_or_b32 v22, v93, 16, v92
    v_lshl_or_b32 v23, v95, 16, v94
    v_lshlrev_b32 v24, 16, v40
    v_and_b32 v25, 0xffff0000, v40
    v_lshlrev_b32 v26, 16, v41
    v_and_b32 v27, 0xffff0000, v41
    v_lshlrev_b32 v28, 16, v42
    v_and_b32 v29, 0xffff0000, v42
    v_lshlrev_b32 v30, 16, v43
    v_and_b32 v31, 0xffff0000, v43
    v_mov_b32 v103, 0xff800000
    v_mov_b32 v104, 0
    v_mov_b32 v105, 0
    s_mov_b32 s60, 0
L_fb_i:
    buffer_load_dword v106, v102, s[4:7], s60 offen
    s_waitcnt vmcnt(0)
    v_lshl_add_u32 v106, v106, 6, v101
    buffer_load_dwordx4 v[44:47], v106, s[8:11], 0 offen
    s_waitcnt vmcnt(0)
    v_lshlrev_b32 v40, 16, v44
    v_and_b32 v41, 0xffff0000, v44
    v_lshlrev_b32 v42, 16, v45
    v_and_b32 v43, 0xffff0000, v45
    v_lshlrev_b32 v44, 16, v46
    v_and_b32 v45, 0xffff0000, v46
    v_lshlrev_b32 v46, 16, v47
    v_and_b32 v47, 0xffff0000, v47
    s_add_u32 s61, s60, 4
L_fb_j:
    buffer_load_dword v106, v102, s[4:7], s61 offen
    s_waitcnt vmcnt(0)
    v_lshl_add_u32 v106, v106, 6, v101
    buffer_load_dwordx4 v[52:55], v106, s[8:11], 0 offen
    s_waitcnt vmcnt(0)
    v_lshlrev_b32 v48, 16, v52
    v_and_b32 v49, 0xffff0000, v52
    v_lshlrev_b32 v50, 16, v53
    v_and_b32 v51, 0xffff0000, v53
    v_lshlrev_b32 v52, 16, v54
    v_and_b32 v53, 0xffff0000, v54
    v_lshlrev_b32 v54, 16, v55
    v_and_b32 v55, 0xffff0000, v55
    v_mul_f32 v48, v48, v40
    v_mul_f32 v49, v49, v41
    v_mul_f32 v50, v50, v42
    v_mul_f32 v51, v51, v43
    v_mul_f32 v52, v52, v44
    v_mul_f32 v53, v53, v45
    v_mul_f32 v54, v54, v46
    v_mul_f32 v55, v55, v47
    v_cvt_pk_bf16_f32 v56, v48, v49
    v_cvt_pk_bf16_f32 v57, v50, v51
    v_cvt_pk_bf16_f32 v58, v52, v53
    v_cvt_pk_bf16_f32 v59, v54, v55
    s_nop 1
    v_mfma_f32_16x16x32_bf16 v[60:63], v[16:19], v[56:59], v[24:27]
    v_mfma_f32_16x16x32_bf16 v[64:67], v[20:23], v[56:59], v[28:31]
    v_mfma_f32_16x16x32_bf16 v[72:75], v[36:39], v[56:59], 0
    s_nop 7
    v_cvt_pk_bf16_f32 v68, v60, v61
    v_cvt_pk_bf16_f32 v69, v62, v63
    v_cvt_pk_bf16_f32 v70, v64, v65
    v_cvt_pk_bf16_f32 v71, v66, v67
    v_pk_max_i16 v68, v68, 0
    v_pk_max_i16 v69, v69, 0
    v_pk_max_i16 v70, v70, 0
    v_pk_max_i16 v71, v71, 0
    s_nop 1
    v_mfma_f32_16x16x32_bf16 v[60:63], v[32:35], v[68:71], 0
    s_nop 7
    v_mul_f32 v60, 0x3fb8aa3b, v60
    v_max_f32 v61, v103, v60
    v_sub_f32 v62, v103, v61
    v_sub_f32 v63, v60, v61
    v_exp_f32 v62, v62
    v_exp_f32 v63, v63
    v_mov_b32 v103, v61
    v_fma_f32 v104, v104, v62, v63
    v_mul_f32 v105, v105, v62
    v_fma_f32 v105, v63, v72, v105
    s_add_u32 s61, s61, 4
    s_cmp_lt_u32 s61, 104
    s_cbranch_scc1 L_fb_j
    s_add_u32 s60, s60, 4
    s_cmp_lt_u32 s60, 100
    s_cbranch_scc1 L_fb_i
    v_rcp_f32 v104, v104
    v_lshlrev_b32 v100, 1, v100
    v_mul_f32 v105, v105, v104
    v_cvt_pk_bf16_f32 v105, v105, v105
    s_mov_b64 exec, 0xffff
    buffer_store_short v105, v100, s[28:31], s55 offen
    s_branch L_fin
L_code_end:
.section .rodata,"a"
.p2align 6
.amdhsa_kernel standalone__factorization_afm__recsys_kernel
  .amdhsa_next_free_vgpr 256
  .amdhsa_next_free_sgpr 102
  .amdhsa_accum_offset 256
  .amdhsa_group_segment_fixed_size 0
  .amdhsa_kernarg_size 88
  .amdhsa_user_sgpr_count 2
  .amdhsa_user_sgpr_kernarg_segment_ptr 1
  .amdhsa_system_sgpr_workgroup_id_x 1
.end_amdhsa_kernel
```
